```python
import torch

def _softmax(x, axis=-1):
    return torch.softmax(x, dim=axis)
def _gelu(x):
    return torch.nn.functional.gelu(x, approximate="tanh")
def _silu(x):
    return torch.nn.functional.silu(x)
def _sigmoid(x):
    return torch.sigmoid(x)
def _layernorm(x, axis=-1, eps=1e-5):
    m = x.mean(dim=axis, keepdim=True)
    v = x.var(dim=axis, keepdim=True, unbiased=False)
    return (x - m) / torch.sqrt(v + eps)
def _scatter_add(tgt, idx, src, axis=0):
    return tgt.clone().index_add_(axis, idx, src)
def _segment_sum(src, seg, n):
    out = torch.zeros((n,) + src.shape[1:], dtype=src.dtype)
    return out.index_add_(0, seg, src)
def _pad(x, pw):
    flat = tuple(v for pair in reversed(pw) for v in pair)
    return torch.nn.functional.pad(x, flat)

kernel_name = 'standalone__detection_seg_fpn_lateral__vision'

def setup_inputs():

    _w = (lambda a: (lambda t: t.to(torch.bfloat16) if t.is_floating_point() else t)(torch.as_tensor(a)))
    H = W = (224 // 2) * 2
    C = 96
    k = 5
    return {
        "c_fine": _w((lambda *s: torch.randn(*s, dtype=torch.bfloat16) * 0.05)(1, H, W, C)),
        "p_coarse": _w((lambda *s: torch.randn(*s, dtype=torch.bfloat16) * 0.05)(1, H // 2, W // 2, C)),
        "w_lat": _w((lambda *s: torch.randn(*s, dtype=torch.bfloat16) * 0.05)(C, C)),
        "w_out": _w((lambda *s: torch.randn(*s, dtype=torch.bfloat16) * 0.05)(k, k, C, C)),
    }

def reference(c_fine, p_coarse, w_lat, w_out):
    B, H, W, C = c_fine.shape
    k = 5
    lat = torch.einsum("bhwc,cd->bhwd", c_fine, w_lat)
    up = (lambda x, n, axis: torch.repeat_interleave(x, n, dim=axis))((lambda x, n, axis: torch.repeat_interleave(x, n, dim=axis))(p_coarse, 2, axis=1), 2, axis=2)
    m = lat + up
    pad = k // 2
    mp = _pad(m, ((0, 0), (pad, pad), (pad, pad), (0, 0)))
    o = None
    for di in range(k):
        for dj in range(k):
            t = torch.einsum("bhwc,cd->bhwd", mp[:, di:di + H, dj:dj + W, :], w_out[di, dj])
            o = t if o is None else o + t
    return o
```

```asm
; @launch grid=(232,1,1) block=(256,1,1) lds=161088
.amdgcn_target "amdgcn-amd-amdhsa--gfx950"
.text
.globl standalone__detection_seg_fpn_lateral__vision_kernel
.p2align 12
.p2align 8
.type standalone__detection_seg_fpn_lateral__vision_kernel,@function
standalone__detection_seg_fpn_lateral__vision_kernel:
    s_load_dwordx8 s[4:11], s[0:1], 0
    s_load_dwordx4 s[12:15], s[0:1], 32
    s_load_dwordx2 s[16:17], s[0:1], 48
    v_lshrrev_b32 v4, 6, v0
    v_and_b32 v1, 63, v0
    v_readfirstlane_b32 s19, v4
    v_lshlrev_b32 v2, 4, v1
    s_getpc_b64 s[48:49]
L_pc:
    s_cmp_ge_u32 s2, 32
    s_cbranch_scc1 L_cons
    s_cmp_lt_u32 s19, 3
    s_cbranch_scc1 L_pfront
    v_lshlrev_b32 v4, 7, v1
    v_mov_b32 v12, s49
    v_min_u32 v5, code_end-L_pc-4, v4
    v_add_co_u32 v6, vcc, s48, v5
    s_nop 1
    v_addc_co_u32 v7, vcc, 0, v12, vcc
    global_load_dword v8, v[6:7], off
    v_add_u32 v4, 8192, v4
    v_min_u32 v5, code_end-L_pc-4, v4
    v_add_co_u32 v6, vcc, s48, v5
    s_nop 1
    v_addc_co_u32 v7, vcc, 0, v12, vcc
    global_load_dword v9, v[6:7], off
    v_add_u32 v4, 8192, v4
    v_min_u32 v5, code_end-L_pc-4, v4
    v_add_co_u32 v6, vcc, s48, v5
    s_nop 1
    v_addc_co_u32 v7, vcc, 0, v12, vcc
    global_load_dword v10, v[6:7], off
    s_branch L_pidle
L_pfront:
    s_cmp_ge_u32 s2, 30
    s_cbranch_scc1 L_end
    s_mul_i32 s51, s2, 26
    s_lshr_b32 s51, s51, 8
    s_mul_i32 s50, s51, 10
    s_sub_u32 s50, s2, s50
    s_and_b32 s52, s50, 1
    s_lshr_b32 s50, s50, 1
    v_cmp_le_u32 vcc, 96, v0
    v_lshlrev_b32 v4, 4, v0
    v_add_u32 v5, 1536, v4
    v_cndmask_b32 v4, v4, v5, vcc
    s_mul_i32 s53, s50, 92160
    s_mul_i32 s3, s51, 6144
    s_add_u32 s53, s53, s3
    s_mul_i32 s3, s52, 1536
    s_add_u32 s53, s53, s3
    s_lshl_b32 m0, s19, 10
    s_mov_b32 s46, 460800
    s_mov_b32 s47, 0x20000
    s_waitcnt lgkmcnt(0)
    s_mov_b64 s[44:45], s[10:11]
    buffer_load_dwordx4 v4, s[44:47], s53 offen offset:0 lds
    s_add_u32 m0, m0, 3072
    s_add_u32 s53, s53, 18432
    buffer_load_dwordx4 v4, s[44:47], s53 offen offset:0 lds
    s_add_u32 m0, m0, 3072
    s_add_u32 s53, s53, 18432
    buffer_load_dwordx4 v4, s[44:47], s53 offen offset:0 lds
    s_add_u32 m0, m0, 3072
    s_add_u32 s53, s53, 18432
    buffer_load_dwordx4 v4, s[44:47], s53 offen offset:0 lds
    s_add_u32 m0, m0, 3072
    s_add_u32 s53, s53, 18432
    buffer_load_dwordx4 v4, s[44:47], s53 offen offset:0 lds
    s_branch L_prod2
L_cons:
    s_movk_i32 s3, 232
    s_bitcmp1_b32 s2, 0
    s_cselect_b32 s3, 224, s3
    s_cmp_ge_u32 s2, s3
    s_cbranch_scc1 L_end
    v_add_u32 v10, 0, v0
    v_mul_u32_u24 v10, 683, v10
    v_lshrrev_b32 v10, 11, v10
    v_and_b32 v10, 32, v10
    v_xor_b32 v20, v2, v10
    v_add_u32 v10, 256, v0
    v_mul_u32_u24 v10, 683, v10
    v_lshrrev_b32 v10, 11, v10
    v_and_b32 v10, 32, v10
    v_xor_b32 v21, v2, v10
    v_add_u32 v10, 512, v0
    v_mul_u32_u24 v10, 683, v10
    v_lshrrev_b32 v10, 11, v10
    v_and_b32 v10, 32, v10
    v_xor_b32 v22, v2, v10
    s_lshl_b32 s63, s19, 10
    s_mov_b32 m0, s63
    s_movk_i32 s30, 18432
    s_mov_b32 s31, 0x20000
    s_sub_u32 s3, s2, 32
    s_and_b32 s50, s3, 7
    s_lshr_b32 s51, s3, 3
    s_lshr_b32 s3, s50, 1
    s_mul_i32 s3, s3, 49
    s_add_u32 s3, s3, s51
    s_and_b32 s50, s50, 1
    s_mul_i32 s50, s50, 25
    s_add_u32 s3, s3, s50
    s_mul_i32 s52, s3, 4682
    s_lshr_b32 s52, s52, 16
    s_mul_i32 s51, s52, 14
    s_sub_u32 s53, s3, s51
    s_lshl_b32 s50, s19, 2
    s_lshl_b32 s51, s52, 4
    s_add_u32 s51, s51, s50
    s_mul_i32 s54, s51, 43008
    s_mul_i32 s3, s53, 3072
    s_add_u32 s54, s54, s3
    s_lshr_b32 s55, s51, 1
    s_mul_i32 s55, s55, 21504
    s_lshr_b32 s3, s3, 1
    s_add_u32 s55, s55, s3
    s_mul_i32 s56, s19, 24640
    s_add_u32 s56, s56, 37888
    s_mul_i32 s3, s19, 129024
    s_sub_u32 s44, s54, s3
    s_add_u32 s44, s44, 688128
    s_waitcnt lgkmcnt(0)
    s_mov_b64 s[28:29], s[8:9]
    buffer_load_dwordx4 v20, s[28:31], s63 offen offset:0 lds
    s_add_u32 m0, m0, 4096
    s_add_u32 s63, s63, 4096
    s_movk_i32 s62, 768
    s_cmp_eq_u32 s53, 13
    s_cselect_b32 s61, 44, 56
    s_cselect_b32 s62, 384, s62
    s_cmp_eq_u32 s53, 0
    s_cselect_b32 s59, 24, 0
    s_cselect_b32 s60, 12, 0
    s_cmp_eq_u32 s51, 0
    s_cselect_b32 s58, 1073741824, 0
    buffer_load_dwordx4 v21, s[28:31], s63 offen offset:0 lds
    s_add_u32 m0, m0, 4096
    s_add_u32 s63, s63, 4096
    v_mov_b32 v3, 0x80000000
    v_cmp_gt_u32 s[64:65], s62, v2
    v_add_u32 v11, 3072, v2
    v_cmp_le_u32 s[66:67], s60, v1
    v_cndmask_b32 v207, v3, v11, s[64:65]
    v_cmp_gt_u32 s[68:69], s61, v1
    v_cndmask_b32 v205, v3, v2, s[66:67]
    v_cmp_le_u32 s[64:65], s59, v1
    v_cndmask_b32 v206, v3, v2, s[68:69]
    v_cmp_gt_u32 vcc, 128, v0
    v_cndmask_b32 v204, v3, v2, s[64:65]
    buffer_load_dwordx4 v22, s[28:31], s63 offen offset:0 lds
    s_add_u32 m0, m0, 4096
    s_add_u32 s63, s63, 4096
    s_sub_u32 s20, s4, 86400
    s_subb_u32 s21, s5, 0
    s_mov_b32 s22, 9720192
    s_mov_b32 s23, 0x20000
    s_add_u32 s48, s48, t_table-L_pc-2048
    s_addc_u32 s49, s49, 0
    v_lshlrev_b32 v12, 10, v4
    v_cndmask_b32 v10, v2, v21, vcc
    v_add_u32 v10, v10, v12
    buffer_load_dwordx4 v20, s[28:31], s63 offen offset:0 lds
    s_add_u32 m0, m0, 4096
    s_add_u32 s63, s63, 4096
    s_add_u32 s64, s8, 16384
    s_addc_u32 s65, s9, 0
    s_cmp_lt_u32 s19, 2
    s_cselect_b32 s64, s64, s48
    s_cselect_b32 s65, s65, s49
    v_mov_b32 v9, s65
    v_add_co_u32 v8, vcc, s64, v10
    s_nop 1
    v_addc_co_u32 v9, vcc, 0, v9, vcc
    global_load_lds_dwordx4 v[8:9], off
    s_mov_b32 exec_hi, 0xffff
    s_add_u32 m0, s56, 21552
    s_nop 0
    buffer_load_dwordx4 v207, s[20:23], s44 offen offset:0 lds
    s_mov_b32 exec_hi, -1
    s_sub_u32 s24, s6, 21696
    s_subb_u32 s25, s7, 0
    s_mov_b32 s26, 2430144
    s_mov_b32 s27, 0x20000
    s_mul_i32 s45, s19, 6160
    s_add_u32 s45, s45, 136448
    s_lshr_b32 s9, s19, 1
    s_lshl_b32 s3, s19, 1
    s_sub_u32 s3, s9, s3
    s_add_u32 s3, s3, 8
    s_mul_i32 s3, s3, 21504
    s_add_u32 s46, s55, s3
    s_add_u32 m0, s45, 3072
    s_nop 0
    buffer_load_dwordx4 v205, s[24:27], s46 offen offset:0 lds
    buffer_load_dwordx4 v206, s[24:27], s46 offen offset:1024 lds
    s_mov_b32 m0, s45
    s_nop 0
    buffer_load_dwordx4 v204, s[20:23], s44 offen offset:0 lds
    buffer_load_dwordx4 v2, s[20:23], s44 offen offset:1024 lds
    buffer_load_dwordx4 v2, s[20:23], s44 offen offset:2048 lds
    s_mov_b32 exec_hi, 0xffff
    s_add_u32 m0, s56, 3072
    s_add_u32 s3, s54, 0
    s_or_b32 s3, s3, s58
    buffer_load_dwordx4 v207, s[20:23], s3 offen offset:0 lds
    s_add_u32 m0, s56, 3840
    s_add_u32 s3, s54, 43008
    s_or_b32 s3, s3, s58
    buffer_load_dwordx4 v207, s[20:23], s3 offen offset:0 lds
    s_add_u32 m0, s56, 4608
    s_add_u32 s3, s54, 86016
    buffer_load_dwordx4 v207, s[20:23], s3 offen offset:0 lds
    s_mov_b32 exec_hi, -1
    s_mov_b32 s32, s16
    s_mov_b32 s33, s17
    s_mov_b32 s34, 737280
    s_mov_b32 s35, 0x20000
    s_mov_b32 s40, s14
    s_mov_b32 s41, s15
    s_mov_b32 s42, 256
    s_mov_b32 s43, 0x20000
    s_mov_b32 s36, s12
    s_mov_b32 s37, s13
    s_mov_b32 s38, 9633792
    s_mov_b32 s39, 0x20000
    s_and_b32 s8, s19, 1
    s_mov_b32 s10, s52
    s_mov_b32 s11, s53
    s_movk_i32 s57, 192
    s_movk_i32 s60, 24640
    s_mul_i32 s5, s9, 12320
    s_sub_u32 s5, 6160, s5
    s_sub_u32 s59, s45, s56
    s_mul_i32 s61, s9, 43376
    s_add_u32 s61, s61, 37888
    s_lshl_b32 s4, s8, 1
    s_add_u32 s4, s4, s9
    s_mul_i32 s18, s4, 184320
    s_mov_b32 s68, 0x05040100
    s_mov_b32 s69, 0x07060100
    v_and_b32 v24, 15, v1
    v_lshrrev_b32 v25, 4, v1
    v_bfe_u32 v27, v1, 2, 2
    v_and_b32 v28, 3, v1
    v_lshlrev_b32 v30, 3, v28
    v_lshl_add_u32 v29, v25, 3, v27
    v_mad_u32_u24 v7, v29, s57, v30
    v_lshlrev_b32 v29, 1, v1
    v_and_b32 v29, 32, v29
    v_sub_u32 v13, v7, v29
    v_add_u32 v7, v7, v29
    v_lshl_add_u32 v26, v25, 4, s56
    v_mad_u32_u24 v4, v24, s57, v26
    v_mad_u32_u24 v6, v27, s57, v26
    v_mul_u32_u24 v29, 768, v28
    v_add_u32 v5, v6, v29
    v_mad_u32_u24 v29, v25, 3, v27
    v_min_u32 v29, 9, v29
    v_mad_u32_u24 v8, v29, s57, v30
    v_add_u32 v8, s56, v8
    v_add_u32 v9, s59, v8
    v_add_u32 v10, s59, v4
    v_lshlrev_b32 v29, 9, v25
    v_lshl_add_u32 v11, v24, 4, v29
    v_add_u32 v11, s56, v11
    v_add_u32 v14, s59, v11
    v_mad_u32_u24 v15, v27, s60, v29
    v_lshl_add_u32 v15, v28, 4, v15
    v_add_u32 v15, s61, v15
    v_add_u32 v16, s5, v15
    v_add_u32 v17, s5, v16
    v_add_u32 v18, s5, v17
    v_add_u32 v19, s5, v18
    v_add_u32 v20, s5, v19
    v_add_u32 v21, s5, v20
    v_add_u32 v22, s5, v21
    v_add_u32 v23, s18, v2
    v_mov_b32 v3, 0
    v_add_u32 v31, 18432, v2
    s_mov_b64 vcc, 0
    s_cmp_eq_u32 s19, 0
    s_cbranch_scc1 L_pad1
L_ret1:
    s_cmp_eq_u32 s19, 1
    s_cbranch_scc1 L_pad2
L_ret2:
    s_cmp_eq_u32 s19, 2
    s_cbranch_scc1 L_pad3
L_ret3:
    s_cmp_eq_u32 s19, 3
    s_cbranch_scc1 L_pad4
L_ret4:
    s_mov_b64 vcc, -1
    s_branch L_body
L_end:
    s_endpgm
.p2align 12
L_body:
    s_waitcnt vmcnt(9)
    s_mov_b32 exec_hi, 0xffff
    s_add_u32 m0, s56, 5376
    s_add_u32 s3, s54, 129024
    buffer_load_dwordx4 v207, s[20:23], s3 offen offset:0 lds
    s_mov_b32 exec_hi, -1
    s_add_u32 m0, s56, 9232
    s_or_b32 s3, s55, s58
    buffer_load_dwordx4 v205, s[24:27], s3 offen offset:0 lds
    buffer_load_dwordx4 v206, s[24:27], s3 offen offset:1024 lds
    s_add_u32 m0, s56, 0
    s_add_u32 s3, s54, 0
    s_or_b32 s3, s3, s58
    buffer_load_dwordx4 v204, s[20:23], s3 offen offset:0 lds
    s_barrier
    ds_read_b64_tr_b16 a[180:181], v7 offset:0
    ds_read_b64_tr_b16 a[182:183], v7 offset:768
    ds_read_b64_tr_b16 a[184:185], v7 offset:6144
    ds_read_b64_tr_b16 a[186:187], v7 offset:6912
    ds_read_b64_tr_b16 a[188:189], v7 offset:12288
    ds_read_b64_tr_b16 a[190:191], v7 offset:13056
    ds_read_b64_tr_b16 a[192:193], v13 offset:32
    ds_read_b64_tr_b16 a[194:195], v13 offset:800
    ds_read_b64_tr_b16 a[196:197], v13 offset:6176
    ds_read_b64_tr_b16 a[198:199], v13 offset:6944
    ds_read_b64_tr_b16 a[200:201], v13 offset:12320
    ds_read_b64_tr_b16 a[202:203], v13 offset:13088
    ds_read_b64_tr_b16 a[204:205], v7 offset:64
    ds_read_b64_tr_b16 a[206:207], v7 offset:832
    ds_read_b64_tr_b16 a[208:209], v7 offset:6208
    ds_read_b64_tr_b16 a[210:211], v7 offset:6976
    ds_read_b64_tr_b16 a[212:213], v7 offset:12352
    ds_read_b64_tr_b16 a[214:215], v7 offset:13120
    ds_read_b64_tr_b16 a[216:217], v13 offset:96
    ds_read_b64_tr_b16 a[218:219], v13 offset:864
    ds_read_b64_tr_b16 a[220:221], v13 offset:6240
    ds_read_b64_tr_b16 a[222:223], v13 offset:7008
    ds_read_b64_tr_b16 a[224:225], v13 offset:12384
    ds_read_b64_tr_b16 a[226:227], v13 offset:13152
    ds_read_b64_tr_b16 a[228:229], v7 offset:128
    ds_read_b64_tr_b16 a[230:231], v7 offset:896
    ds_read_b64_tr_b16 a[232:233], v7 offset:6272
    ds_read_b64_tr_b16 a[234:235], v7 offset:7040
    ds_read_b64_tr_b16 a[236:237], v7 offset:12416
    ds_read_b64_tr_b16 a[238:239], v7 offset:13184
    ds_read_b64_tr_b16 a[240:241], v13 offset:160
    ds_read_b64_tr_b16 a[242:243], v13 offset:928
    ds_read_b64_tr_b16 a[244:245], v13 offset:6304
    ds_read_b64_tr_b16 a[246:247], v13 offset:7072
    ds_read_b64_tr_b16 a[248:249], v13 offset:12448
    ds_read_b64_tr_b16 a[250:251], v13 offset:13216
    ds_read_b128 v[32:35], v31 offset:0
    ds_read_b128 v[36:39], v31 offset:1024
    s_waitcnt vmcnt(12)
    ds_read_b128 v[40:43], v6 offset:21552
    ds_read_b128 v[44:47], v6 offset:21616
    ds_read_b128 v[48:51], v6 offset:21680
    s_waitcnt lgkmcnt(0)
    v_mfma_f32_16x16x32_bf16 v[64:67], v[40:43], a[180:183], 0
    buffer_load_dwordx4 v2, s[20:23], s3 offen offset:1024 lds
    v_mfma_f32_16x16x32_bf16 v[64:67], v[44:47], a[184:187], v[64:67]
    v_mfma_f32_16x16x32_bf16 v[64:67], v[48:51], a[188:191], v[64:67]
    buffer_load_dwordx4 v2, s[20:23], s3 offen offset:2048 lds
    v_mfma_f32_16x16x32_bf16 v[68:71], v[40:43], a[192:195], 0
    v_mfma_f32_16x16x32_bf16 v[68:71], v[44:47], a[196:199], v[68:71]
    v_mfma_f32_16x16x32_bf16 v[68:71], v[48:51], a[200:203], v[68:71]
    v_mfma_f32_16x16x32_bf16 v[72:75], v[40:43], a[204:207], 0
    v_mfma_f32_16x16x32_bf16 v[72:75], v[44:47], a[208:211], v[72:75]
    s_nop 1
    v_cvt_pk_bf16_f32 v100, v64, v65
    v_mfma_f32_16x16x32_bf16 v[72:75], v[48:51], a[212:215], v[72:75]
    v_mfma_f32_16x16x32_bf16 v[76:79], v[40:43], a[216:219], 0
    v_mfma_f32_16x16x32_bf16 v[76:79], v[44:47], a[220:223], v[76:79]
    v_cvt_pk_bf16_f32 v101, v68, v69
    v_mfma_f32_16x16x32_bf16 v[76:79], v[48:51], a[224:227], v[76:79]
    s_waitcnt vmcnt(9)
    ds_read_b128 v[52:55], v10 offset:0
    v_mfma_f32_16x16x32_bf16 v[80:83], v[40:43], a[228:231], 0
    ds_read_b128 v[56:59], v10 offset:64
    v_mfma_f32_16x16x32_bf16 v[80:83], v[44:47], a[232:235], v[80:83]
    ds_read_b128 v[60:63], v10 offset:128
    v_cvt_pk_bf16_f32 v102, v72, v73
    v_mfma_f32_16x16x32_bf16 v[80:83], v[48:51], a[236:239], v[80:83]
    ds_read_b64_tr_b16 v[110:111], v9 offset:3072
    s_add_u32 m0, s56, 6160
    v_mfma_f32_16x16x32_bf16 v[84:87], v[40:43], a[240:243], 0
    ds_read_b64_tr_b16 v[114:115], v9 offset:3104
    s_add_u32 s3, s54, 43008
    v_mfma_f32_16x16x32_bf16 v[84:87], v[44:47], a[244:247], v[84:87]
    ds_read_b64_tr_b16 v[118:119], v9 offset:3136
    s_or_b32 s3, s3, s58
    v_mfma_f32_16x16x32_bf16 v[84:87], v[48:51], a[248:251], v[84:87]
    s_waitcnt lgkmcnt(3)
    ds_read_b64_tr_b16 v[122:123], v9 offset:3168
    v_mfma_f32_16x16x32_bf16 v[64:67], v[52:55], a[180:183], 0
    buffer_load_dwordx4 v204, s[20:23], s3 offen offset:0 lds
    ds_read_b64_tr_b16 v[126:127], v9 offset:3200
    v_mfma_f32_16x16x32_bf16 v[64:67], v[56:59], a[184:187], v[64:67]
    ds_read_b64_tr_b16 v[130:131], v9 offset:3232
    v_cvt_pk_bf16_f32 v103, v76, v77
    v_mfma_f32_16x16x32_bf16 v[64:67], v[60:63], a[188:191], v[64:67]
    buffer_load_dwordx4 v2, s[20:23], s3 offen offset:1024 lds
    v_mfma_f32_16x16x32_bf16 v[68:71], v[52:55], a[192:195], 0
    v_cvt_pk_bf16_f32 v104, v80, v81
    v_mfma_f32_16x16x32_bf16 v[68:71], v[56:59], a[196:199], v[68:71]
    s_waitcnt lgkmcnt(3)
    v_perm_b32 v111, v100, v111, s68
    v_perm_b32 v115, v101, v115, s68
    v_mfma_f32_16x16x32_bf16 v[68:71], v[60:63], a[200:203], v[68:71]
    buffer_load_dwordx4 v2, s[20:23], s3 offen offset:2048 lds
    v_mfma_f32_16x16x32_bf16 v[72:75], v[52:55], a[204:207], 0
    v_cvt_pk_bf16_f32 v108, v64, v65
    v_cvt_pk_bf16_f32 v109, v66, v67
    v_mfma_f32_16x16x32_bf16 v[72:75], v[56:59], a[208:211], v[72:75]
    s_waitcnt lgkmcnt(0)
    s_add_u32 m0, s56, 15392
    s_add_u32 s3, s55, 21504
    v_mfma_f32_16x16x32_bf16 v[72:75], v[60:63], a[212:215], v[72:75]
    buffer_load_dwordx4 v205, s[24:27], s3 offen offset:0 lds
    v_mfma_f32_16x16x32_bf16 v[132:135], v[108:111], v[32:35], 0
    v_cvt_pk_bf16_f32 v112, v68, v69
    v_cvt_pk_bf16_f32 v113, v70, v71
    v_mfma_f32_16x16x32_bf16 v[136:139], v[108:111], v[36:39], 0
    buffer_load_dwordx4 v206, s[24:27], s3 offen offset:1024 lds
    v_mfma_f32_16x16x32_bf16 v[76:79], v[52:55], a[216:219], 0
    v_perm_b32 v119, v102, v119, s68
    v_cvt_pk_bf16_f32 v116, v72, v73
    v_mfma_f32_16x16x32_bf16 v[76:79], v[56:59], a[220:223], v[76:79]
    v_cvt_pk_bf16_f32 v117, v74, v75
    v_cvt_pk_bf16_f32 v180, v132, v133
    v_mfma_f32_16x16x32_bf16 v[76:79], v[60:63], a[224:227], v[76:79]
    v_cvt_pk_bf16_f32 v181, v134, v135
    v_cvt_pk_bf16_f32 v105, v84, v85
    v_mfma_f32_16x16x32_bf16 v[140:143], v[112:115], v[32:35], 0
    v_cvt_pk_bf16_f32 v184, v136, v137
    v_cvt_pk_bf16_f32 v185, v138, v139
    v_mfma_f32_16x16x32_bf16 v[144:147], v[112:115], v[36:39], 0
    v_perm_b32 v123, v103, v123, s68
    v_mfma_f32_16x16x32_bf16 v[80:83], v[52:55], a[228:231], 0
    v_cvt_pk_bf16_f32 v120, v76, v77
    v_cvt_pk_bf16_f32 v121, v78, v79
    v_mfma_f32_16x16x32_bf16 v[80:83], v[56:59], a[232:235], v[80:83]
    v_cvt_pk_bf16_f32 v182, v140, v141
    v_cvt_pk_bf16_f32 v183, v142, v143
    v_mfma_f32_16x16x32_bf16 v[80:83], v[60:63], a[236:239], v[80:83]
    ds_write_b128 v14, v[180:183] offset:0
    v_mfma_f32_16x16x32_bf16 v[148:151], v[116:119], v[32:35], 0
    v_cvt_pk_bf16_f32 v186, v144, v145
    v_cvt_pk_bf16_f32 v187, v146, v147
    v_mfma_f32_16x16x32_bf16 v[152:155], v[116:119], v[36:39], 0
    v_perm_b32 v127, v104, v127, s68
    v_mfma_f32_16x16x32_bf16 v[84:87], v[52:55], a[240:243], 0
    ds_write_b128 v14, v[184:187] offset:256
    v_mfma_f32_16x16x32_bf16 v[84:87], v[56:59], a[244:247], v[84:87]
    v_cvt_pk_bf16_f32 v124, v80, v81
    v_cvt_pk_bf16_f32 v125, v82, v83
    v_cvt_pk_bf16_f32 v189, v150, v151
    v_mfma_f32_16x16x32_bf16 v[84:87], v[60:63], a[248:251], v[84:87]
    s_waitcnt vmcnt(10)
    ds_read_b128 v[40:43], v5 offset:3072
    v_mfma_f32_16x16x32_bf16 v[156:159], v[120:123], v[32:35], 0
    ds_read_b128 v[44:47], v5 offset:3136
    v_perm_b32 v131, v105, v131, s68
    v_mfma_f32_16x16x32_bf16 v[160:163], v[120:123], v[36:39], 0
    ds_read_b128 v[48:51], v5 offset:3200
    v_cvt_pk_bf16_f32 v188, v148, v149
    v_mfma_f32_16x16x32_bf16 v[164:167], v[124:127], v[32:35], 0
    s_add_u32 m0, s56, 12320
    s_add_u32 s3, s54, 86016
    v_cvt_pk_bf16_f32 v128, v84, v85
    v_cvt_pk_bf16_f32 v129, v86, v87
    v_mfma_f32_16x16x32_bf16 v[168:171], v[124:127], v[36:39], 0
    buffer_load_dwordx4 v204, s[20:23], s3 offen offset:0 lds
    v_cvt_pk_bf16_f32 v190, v156, v157
    v_cvt_pk_bf16_f32 v191, v158, v159
    v_mfma_f32_16x16x32_bf16 v[172:175], v[128:131], v[32:35], 0
    ds_write_b128 v14, v[188:191] offset:2048
    v_cvt_pk_bf16_f32 v194, v160, v161
    v_cvt_pk_bf16_f32 v195, v162, v163
    v_mfma_f32_16x16x32_bf16 v[176:179], v[128:131], v[36:39], 0
    s_waitcnt lgkmcnt(1)
    v_cvt_pk_bf16_f32 v192, v152, v153
    v_cvt_pk_bf16_f32 v193, v154, v155
    v_mfma_f32_16x16x32_bf16 v[64:67], v[40:43], a[180:183], 0
    buffer_load_dwordx4 v2, s[20:23], s3 offen offset:1024 lds
    v_mfma_f32_16x16x32_bf16 v[64:67], v[44:47], a[184:187], v[64:67]
    ds_write_b128 v14, v[192:195] offset:2304
    v_mfma_f32_16x16x32_bf16 v[64:67], v[48:51], a[188:191], v[64:67]
    buffer_load_dwordx4 v2, s[20:23], s3 offen offset:2048 lds
    v_mfma_f32_16x16x32_bf16 v[68:71], v[40:43], a[192:195], 0
    v_cvt_pk_bf16_f32 v196, v164, v165
    v_cvt_pk_bf16_f32 v197, v166, v167
    v_mfma_f32_16x16x32_bf16 v[68:71], v[44:47], a[196:199], v[68:71]
    v_cvt_pk_bf16_f32 v198, v172, v173
    v_cvt_pk_bf16_f32 v199, v174, v175
    v_mfma_f32_16x16x32_bf16 v[68:71], v[48:51], a[200:203], v[68:71]
    v_cvt_pk_bf16_f32 v200, v168, v169
    v_cvt_pk_bf16_f32 v201, v170, v171
    v_mfma_f32_16x16x32_bf16 v[72:75], v[40:43], a[204:207], 0
    v_cvt_pk_bf16_f32 v202, v176, v177
    v_cvt_pk_bf16_f32 v203, v178, v179
    v_mfma_f32_16x16x32_bf16 v[72:75], v[44:47], a[208:211], v[72:75]
    v_cvt_pk_bf16_f32 v88, v64, v65
    v_cvt_pk_bf16_f32 v89, v66, v67
    v_mfma_f32_16x16x32_bf16 v[72:75], v[48:51], a[212:215], v[72:75]
    ds_write_b128 v14, v[196:199] offset:4096
    v_mfma_f32_16x16x32_bf16 v[76:79], v[40:43], a[216:219], 0
    v_mfma_f32_16x16x32_bf16 v[76:79], v[44:47], a[220:223], v[76:79]
    v_cvt_pk_bf16_f32 v90, v68, v69
    v_cvt_pk_bf16_f32 v91, v70, v71
    v_mfma_f32_16x16x32_bf16 v[76:79], v[48:51], a[224:227], v[76:79]
    ds_write_b128 v14, v[200:203] offset:4352
    v_mfma_f32_16x16x32_bf16 v[80:83], v[40:43], a[228:231], 0
    s_waitcnt vmcnt(8)
    v_mfma_f32_16x16x32_bf16 v[80:83], v[44:47], a[232:235], v[80:83]
    ds_read_b128 v[52:55], v4 offset:0
    v_cvt_pk_bf16_f32 v92, v72, v73
    v_mfma_f32_16x16x32_bf16 v[80:83], v[48:51], a[236:239], v[80:83]
    ds_read_b128 v[56:59], v4 offset:64
    v_cvt_pk_bf16_f32 v93, v74, v75
    v_mfma_f32_16x16x32_bf16 v[84:87], v[40:43], a[240:243], 0
    ds_read_b128 v[60:63], v4 offset:128
    v_mfma_f32_16x16x32_bf16 v[84:87], v[44:47], a[244:247], v[84:87]
    ds_read_b64_tr_b16 v[110:111], v8 offset:9232
    s_add_u32 m0, s56, 18480
    v_mfma_f32_16x16x32_bf16 v[84:87], v[48:51], a[248:251], v[84:87]
    s_waitcnt lgkmcnt(1)
    ds_read_b64_tr_b16 v[114:115], v8 offset:9264
    v_mfma_f32_16x16x32_bf16 v[64:67], v[52:55], a[180:183], 0
    ds_read_b64_tr_b16 v[118:119], v8 offset:9296
    s_add_u32 s3, s54, 129024
    v_mfma_f32_16x16x32_bf16 v[64:67], v[56:59], a[184:187], v[64:67]
    buffer_load_dwordx4 v204, s[20:23], s3 offen offset:0 lds
    ds_read_b64_tr_b16 v[122:123], v8 offset:9328
    v_mfma_f32_16x16x32_bf16 v[64:67], v[60:63], a[188:191], v[64:67]
    ds_read_b64_tr_b16 v[126:127], v8 offset:9360
    v_cvt_pk_bf16_f32 v94, v76, v77
    v_mfma_f32_16x16x32_bf16 v[68:71], v[52:55], a[192:195], 0
    ds_read_b64_tr_b16 v[130:131], v8 offset:9392
    v_cvt_pk_bf16_f32 v95, v78, v79
    v_mfma_f32_16x16x32_bf16 v[68:71], v[56:59], a[196:199], v[68:71]
    buffer_load_dwordx4 v2, s[20:23], s3 offen offset:1024 lds
    v_mfma_f32_16x16x32_bf16 v[68:71], v[60:63], a[200:203], v[68:71]
    v_cvt_pk_bf16_f32 v108, v64, v65
    v_cvt_pk_bf16_f32 v109, v66, v67
    v_mfma_f32_16x16x32_bf16 v[72:75], v[52:55], a[204:207], 0
    s_waitcnt lgkmcnt(3)
    v_perm_b32 v111, v88, v111, s68
    v_perm_b32 v115, v90, v115, s68
    v_mfma_f32_16x16x32_bf16 v[72:75], v[56:59], a[208:211], v[72:75]
    buffer_load_dwordx4 v2, s[20:23], s3 offen offset:2048 lds
    v_mfma_f32_16x16x32_bf16 v[72:75], v[60:63], a[212:215], v[72:75]
    v_cvt_pk_bf16_f32 v112, v68, v69
    v_cvt_pk_bf16_f32 v113, v70, v71
    v_mfma_f32_16x16x32_bf16 v[132:135], v[108:111], v[32:35], 0
    s_waitcnt lgkmcnt(0)
    v_cvt_pk_bf16_f32 v96, v80, v81
    v_cvt_pk_bf16_f32 v97, v82, v83
    v_mfma_f32_16x16x32_bf16 v[136:139], v[108:111], v[36:39], 0
    v_perm_b32 v119, v92, v119, s68
    v_cvt_pk_bf16_f32 v98, v84, v85
    v_mfma_f32_16x16x32_bf16 v[76:79], v[52:55], a[216:219], 0
    v_cvt_pk_bf16_f32 v116, v72, v73
    v_cvt_pk_bf16_f32 v117, v74, v75
    v_mfma_f32_16x16x32_bf16 v[76:79], v[56:59], a[220:223], v[76:79]
    v_cvt_pk_bf16_f32 v180, v132, v133
    v_cvt_pk_bf16_f32 v181, v134, v135
    v_mfma_f32_16x16x32_bf16 v[76:79], v[60:63], a[224:227], v[76:79]
    v_cvt_pk_bf16_f32 v99, v86, v87
    v_cvt_pk_bf16_f32 v184, v136, v137
    v_mfma_f32_16x16x32_bf16 v[140:143], v[112:115], v[32:35], 0
    v_cvt_pk_bf16_f32 v185, v138, v139
    v_perm_b32 v123, v94, v123, s68
    v_mfma_f32_16x16x32_bf16 v[144:147], v[112:115], v[36:39], 0
    v_perm_b32 v111, v88, v111, s69
    v_perm_b32 v115, v90, v115, s69
    v_mfma_f32_16x16x32_bf16 v[80:83], v[52:55], a[228:231], 0
    v_cvt_pk_bf16_f32 v120, v76, v77
    v_cvt_pk_bf16_f32 v121, v78, v79
    v_mfma_f32_16x16x32_bf16 v[80:83], v[56:59], a[232:235], v[80:83]
    v_cvt_pk_bf16_f32 v182, v140, v141
    v_cvt_pk_bf16_f32 v183, v142, v143
    v_mfma_f32_16x16x32_bf16 v[80:83], v[60:63], a[236:239], v[80:83]
    ds_write_b128 v11, v[180:183] offset:0
    v_mfma_f32_16x16x32_bf16 v[148:151], v[116:119], v[32:35], 0
    v_cvt_pk_bf16_f32 v186, v144, v145
    v_cvt_pk_bf16_f32 v187, v146, v147
    v_mfma_f32_16x16x32_bf16 v[152:155], v[116:119], v[36:39], 0
    v_perm_b32 v127, v96, v127, s68
    v_perm_b32 v119, v92, v119, s69
    v_mfma_f32_16x16x32_bf16 v[84:87], v[52:55], a[240:243], 0
    ds_write_b128 v11, v[184:187] offset:256
    v_mfma_f32_16x16x32_bf16 v[84:87], v[56:59], a[244:247], v[84:87]
    v_cvt_pk_bf16_f32 v124, v80, v81
    v_cvt_pk_bf16_f32 v125, v82, v83
    v_mfma_f32_16x16x32_bf16 v[84:87], v[60:63], a[248:251], v[84:87]
    s_waitcnt vmcnt(8)
    ds_read_b128 v[40:43], v4 offset:6160
    v_mfma_f32_16x16x32_bf16 v[156:159], v[120:123], v[32:35], 0
    ds_read_b128 v[44:47], v4 offset:6224
    v_perm_b32 v131, v98, v131, s68
    v_mfma_f32_16x16x32_bf16 v[160:163], v[120:123], v[36:39], 0
    ds_read_b128 v[48:51], v4 offset:6288
    v_cvt_pk_bf16_f32 v188, v148, v149
    v_mfma_f32_16x16x32_bf16 v[164:167], v[124:127], v[32:35], 0
    v_cvt_pk_bf16_f32 v128, v84, v85
    v_cvt_pk_bf16_f32 v129, v86, v87
    v_mfma_f32_16x16x32_bf16 v[168:171], v[124:127], v[36:39], 0
    v_cvt_pk_bf16_f32 v189, v150, v151
    v_cvt_pk_bf16_f32 v190, v156, v157
    v_cvt_pk_bf16_f32 v191, v158, v159
    v_mfma_f32_16x16x32_bf16 v[172:175], v[128:131], v[32:35], 0
    ds_write_b128 v11, v[188:191] offset:2048
    v_mfma_f32_16x16x32_bf16 v[176:179], v[128:131], v[36:39], 0
    s_waitcnt lgkmcnt(1)
    v_cvt_pk_bf16_f32 v192, v152, v153
    v_cvt_pk_bf16_f32 v193, v154, v155
    v_mfma_f32_16x16x32_bf16 v[64:67], v[40:43], a[180:183], 0
    v_cvt_pk_bf16_f32 v194, v160, v161
    v_cvt_pk_bf16_f32 v195, v162, v163
    v_mfma_f32_16x16x32_bf16 v[64:67], v[44:47], a[184:187], v[64:67]
    ds_write_b128 v11, v[192:195] offset:2304
    v_mfma_f32_16x16x32_bf16 v[64:67], v[48:51], a[188:191], v[64:67]
    v_cvt_pk_bf16_f32 v196, v164, v165
    v_cvt_pk_bf16_f32 v197, v166, v167
    v_mfma_f32_16x16x32_bf16 v[68:71], v[40:43], a[192:195], 0
    v_cvt_pk_bf16_f32 v198, v172, v173
    v_cvt_pk_bf16_f32 v199, v174, v175
    v_mfma_f32_16x16x32_bf16 v[68:71], v[44:47], a[196:199], v[68:71]
    v_cvt_pk_bf16_f32 v200, v168, v169
    v_cvt_pk_bf16_f32 v201, v170, v171
    v_mfma_f32_16x16x32_bf16 v[68:71], v[48:51], a[200:203], v[68:71]
    v_cvt_pk_bf16_f32 v108, v64, v65
    v_cvt_pk_bf16_f32 v109, v66, v67
    v_mfma_f32_16x16x32_bf16 v[72:75], v[40:43], a[204:207], 0
    v_cvt_pk_bf16_f32 v202, v176, v177
    v_cvt_pk_bf16_f32 v203, v178, v179
    v_mfma_f32_16x16x32_bf16 v[72:75], v[44:47], a[208:211], v[72:75]
    v_perm_b32 v123, v94, v123, s69
    v_perm_b32 v127, v96, v127, s69
    v_mfma_f32_16x16x32_bf16 v[72:75], v[48:51], a[212:215], v[72:75]
    ds_write_b128 v11, v[196:199] offset:4096
    v_mfma_f32_16x16x32_bf16 v[132:135], v[108:111], v[32:35], 0
    v_cvt_pk_bf16_f32 v112, v68, v69
    v_cvt_pk_bf16_f32 v113, v70, v71
    v_mfma_f32_16x16x32_bf16 v[136:139], v[108:111], v[36:39], 0
    v_perm_b32 v131, v98, v131, s69
    v_mfma_f32_16x16x32_bf16 v[76:79], v[40:43], a[216:219], 0
    ds_write_b128 v11, v[200:203] offset:4352
    v_mfma_f32_16x16x32_bf16 v[76:79], v[44:47], a[220:223], v[76:79]
    v_cvt_pk_bf16_f32 v116, v72, v73
    v_cvt_pk_bf16_f32 v117, v74, v75
    v_mfma_f32_16x16x32_bf16 v[76:79], v[48:51], a[224:227], v[76:79]
    v_cvt_pk_bf16_f32 v180, v132, v133
    v_cvt_pk_bf16_f32 v181, v134, v135
    v_mfma_f32_16x16x32_bf16 v[140:143], v[112:115], v[32:35], 0
    v_cvt_pk_bf16_f32 v184, v136, v137
    v_cvt_pk_bf16_f32 v185, v138, v139
    v_mfma_f32_16x16x32_bf16 v[144:147], v[112:115], v[36:39], 0
    v_mfma_f32_16x16x32_bf16 v[80:83], v[40:43], a[228:231], 0
    s_nop 0
    v_cvt_pk_bf16_f32 v120, v76, v77
    v_cvt_pk_bf16_f32 v121, v78, v79
    v_mfma_f32_16x16x32_bf16 v[80:83], v[44:47], a[232:235], v[80:83]
    v_cvt_pk_bf16_f32 v182, v140, v141
    v_cvt_pk_bf16_f32 v183, v142, v143
    v_mfma_f32_16x16x32_bf16 v[80:83], v[48:51], a[236:239], v[80:83]
    ds_write_b128 v11, v[180:183] offset:6160
    v_mfma_f32_16x16x32_bf16 v[148:151], v[116:119], v[32:35], 0
    s_load_dword s50, s[14:15], 0
    v_cvt_pk_bf16_f32 v186, v144, v145
    v_cvt_pk_bf16_f32 v187, v146, v147
    v_mfma_f32_16x16x32_bf16 v[152:155], v[116:119], v[36:39], 0
    v_mfma_f32_16x16x32_bf16 v[84:87], v[40:43], a[240:243], 0
    ds_write_b128 v11, v[184:187] offset:6416
    v_mfma_f32_16x16x32_bf16 v[84:87], v[44:47], a[244:247], v[84:87]
    v_cvt_pk_bf16_f32 v124, v80, v81
    v_cvt_pk_bf16_f32 v125, v82, v83
    v_mfma_f32_16x16x32_bf16 v[84:87], v[48:51], a[248:251], v[84:87]
    s_waitcnt vmcnt(3)
    ds_read_b128 v[52:55], v4 offset:12320
    v_mfma_f32_16x16x32_bf16 v[156:159], v[120:123], v[32:35], 0
    ds_read_b128 v[56:59], v4 offset:12384
    v_cvt_pk_bf16_f32 v188, v148, v149
    v_mfma_f32_16x16x32_bf16 v[160:163], v[120:123], v[36:39], 0
    ds_read_b128 v[60:63], v4 offset:12448
    v_cvt_pk_bf16_f32 v189, v150, v151
    v_mfma_f32_16x16x32_bf16 v[164:167], v[124:127], v[32:35], 0
    ds_read_b64_tr_b16 v[110:111], v8 offset:15392
    v_cvt_pk_bf16_f32 v128, v84, v85
    v_cvt_pk_bf16_f32 v129, v86, v87
    v_mfma_f32_16x16x32_bf16 v[168:171], v[124:127], v[36:39], 0
    ds_read_b64_tr_b16 v[114:115], v8 offset:15424
    v_cvt_pk_bf16_f32 v190, v156, v157
    v_cvt_pk_bf16_f32 v191, v158, v159
    v_mfma_f32_16x16x32_bf16 v[172:175], v[128:131], v[32:35], 0
    ds_write_b128 v11, v[188:191] offset:8208
    v_cvt_pk_bf16_f32 v195, v162, v163
    v_mfma_f32_16x16x32_bf16 v[176:179], v[128:131], v[36:39], 0
    s_waitcnt lgkmcnt(3)
    v_cvt_pk_bf16_f32 v192, v152, v153
    v_cvt_pk_bf16_f32 v193, v154, v155
    v_mfma_f32_16x16x32_bf16 v[64:67], v[52:55], a[180:183], 0
    ds_read_b64_tr_b16 v[118:119], v8 offset:15456
    v_cvt_pk_bf16_f32 v194, v160, v161
    v_mfma_f32_16x16x32_bf16 v[64:67], v[56:59], a[184:187], v[64:67]
    ds_write_b128 v11, v[192:195] offset:8464
    v_mfma_f32_16x16x32_bf16 v[64:67], v[60:63], a[188:191], v[64:67]
    v_cvt_pk_bf16_f32 v196, v164, v165
    v_cvt_pk_bf16_f32 v197, v166, v167
    v_cvt_pk_bf16_f32 v203, v178, v179
    v_mfma_f32_16x16x32_bf16 v[68:71], v[52:55], a[192:195], 0
    ds_read_b64_tr_b16 v[122:123], v8 offset:15488
    v_cvt_pk_bf16_f32 v198, v172, v173
    v_mfma_f32_16x16x32_bf16 v[68:71], v[56:59], a[196:199], v[68:71]
    ds_read_b64_tr_b16 v[126:127], v8 offset:15520
    s_waitcnt lgkmcnt(0)
    v_mfma_f32_16x16x32_bf16 v[68:71], v[60:63], a[200:203], v[68:71]
    ds_read_b64_tr_b16 v[130:131], v8 offset:15552
    s_cmp_ge_u32 s50, 10
    v_cvt_pk_bf16_f32 v109, v66, v67
    v_mfma_f32_16x16x32_bf16 v[72:75], v[52:55], a[204:207], 0
    s_cselect_b32 s34, 737280, 0
    v_cvt_pk_bf16_f32 v199, v174, v175
    v_perm_b32 v111, v89, v111, s68
    v_perm_b32 v115, v91, v115, s68
    v_mfma_f32_16x16x32_bf16 v[72:75], v[56:59], a[208:211], v[72:75]
    buffer_load_dwordx4 a[0:3], v23, s[32:35], 0 offen offset:0 sc1
    v_cvt_pk_bf16_f32 v108, v64, v65
    v_mfma_f32_16x16x32_bf16 v[72:75], v[60:63], a[212:215], v[72:75]
    ds_write_b128 v11, v[196:199] offset:10256
    v_cvt_pk_bf16_f32 v112, v68, v69
    v_cvt_pk_bf16_f32 v113, v70, v71
    v_mfma_f32_16x16x32_bf16 v[132:135], v[108:111], v[32:35], 0
    buffer_load_dwordx4 a[4:7], v23, s[32:35], 0 offen offset:1024 sc1
    v_cvt_pk_bf16_f32 v200, v168, v169
    v_mfma_f32_16x16x32_bf16 v[136:139], v[108:111], v[36:39], 0
    v_cvt_pk_bf16_f32 v201, v170, v171
    v_cvt_pk_bf16_f32 v202, v176, v177
    v_mfma_f32_16x16x32_bf16 v[76:79], v[52:55], a[216:219], 0
    ds_write_b128 v11, v[200:203] offset:10512
    v_mfma_f32_16x16x32_bf16 v[76:79], v[56:59], a[220:223], v[76:79]
    s_waitcnt lgkmcnt(2)
    buffer_load_dwordx4 a[8:11], v23, s[32:35], 0 offen offset:2048 sc1
    v_perm_b32 v127, v97, v127, s68
    v_mfma_f32_16x16x32_bf16 v[76:79], v[60:63], a[224:227], v[76:79]
    v_perm_b32 v119, v93, v119, s68
    v_cvt_pk_bf16_f32 v116, v72, v73
    v_mfma_f32_16x16x32_bf16 v[140:143], v[112:115], v[32:35], 0
    buffer_load_dwordx4 a[12:15], v23, s[32:35], 0 offen offset:3072 sc1
    v_add_u32 v23, 4096, v23
    v_mfma_f32_16x16x32_bf16 v[144:147], v[112:115], v[36:39], 0
    v_cvt_pk_bf16_f32 v117, v74, v75
    v_cvt_pk_bf16_f32 v180, v132, v133
    v_mfma_f32_16x16x32_bf16 v[80:83], v[52:55], a[228:231], 0
    buffer_load_dwordx4 a[16:19], v23, s[32:35], 0 offen offset:0 sc1
    v_cvt_pk_bf16_f32 v181, v134, v135
    v_cvt_pk_bf16_f32 v120, v76, v77
    v_cvt_pk_bf16_f32 v121, v78, v79
    v_mfma_f32_16x16x32_bf16 v[80:83], v[56:59], a[232:235], v[80:83]
    v_cvt_pk_bf16_f32 v182, v140, v141
    v_cvt_pk_bf16_f32 v183, v142, v143
    v_mfma_f32_16x16x32_bf16 v[80:83], v[60:63], a[236:239], v[80:83]
    ds_write_b128 v11, v[180:183] offset:12320
    v_cvt_pk_bf16_f32 v187, v146, v147
    v_mfma_f32_16x16x32_bf16 v[148:151], v[116:119], v[32:35], 0
    buffer_load_dwordx4 a[20:23], v23, s[32:35], 0 offen offset:1024 sc1
    v_cvt_pk_bf16_f32 v184, v136, v137
    v_mfma_f32_16x16x32_bf16 v[152:155], v[116:119], v[36:39], 0
    v_cvt_pk_bf16_f32 v185, v138, v139
    v_cvt_pk_bf16_f32 v186, v144, v145
    v_mfma_f32_16x16x32_bf16 v[84:87], v[52:55], a[240:243], 0
    ds_write_b128 v11, v[184:187] offset:12576
    v_cvt_pk_bf16_f32 v124, v80, v81
    v_cvt_pk_bf16_f32 v125, v82, v83
    v_mfma_f32_16x16x32_bf16 v[84:87], v[56:59], a[244:247], v[84:87]
    buffer_load_dwordx4 a[24:27], v23, s[32:35], 0 offen offset:2048 sc1
    v_perm_b32 v123, v95, v123, s68
    v_mfma_f32_16x16x32_bf16 v[84:87], v[60:63], a[248:251], v[84:87]
    s_waitcnt vmcnt(7)
    ds_read_b128 v[40:43], v4 offset:18480
    v_mfma_f32_16x16x32_bf16 v[156:159], v[120:123], v[32:35], 0
    buffer_load_dwordx4 a[28:31], v23, s[32:35], 0 offen offset:3072 sc1
    ds_read_b128 v[44:47], v4 offset:18544
    v_mfma_f32_16x16x32_bf16 v[160:163], v[120:123], v[36:39], 0
    ds_read_b128 v[48:51], v4 offset:18608
    v_add_u32 v23, 4096, v23
    v_mfma_f32_16x16x32_bf16 v[164:167], v[124:127], v[32:35], 0
    v_perm_b32 v131, v99, v131, s68
    v_cvt_pk_bf16_f32 v128, v84, v85
    v_cvt_pk_bf16_f32 v129, v86, v87
    v_mfma_f32_16x16x32_bf16 v[168:171], v[124:127], v[36:39], 0
    buffer_load_dwordx4 a[32:35], v23, s[32:35], 0 offen offset:0 sc1
    v_perm_b32 v111, v89, v111, s69
    v_mfma_f32_16x16x32_bf16 v[172:175], v[128:131], v[32:35], 0
    v_perm_b32 v115, v91, v115, s69
    v_perm_b32 v119, v93, v119, s69
    v_mfma_f32_16x16x32_bf16 v[176:179], v[128:131], v[36:39], 0
    s_waitcnt lgkmcnt(0)
    v_perm_b32 v123, v95, v123, s69
    v_perm_b32 v127, v97, v127, s69
    v_mfma_f32_16x16x32_bf16 v[64:67], v[40:43], a[180:183], 0
    s_cmp_eq_u32 s34, 0
    s_cbranch_scc1 L_slow
L_go:
    v_mfma_f32_16x16x32_bf16 v[64:67], v[44:47], a[184:187], v[64:67]
    buffer_load_dwordx4 a[36:39], v23, s[32:35], 0 offen offset:1024 sc1
    v_perm_b32 v131, v99, v131, s69
    v_mfma_f32_16x16x32_bf16 v[64:67], v[48:51], a[188:191], v[64:67]
    v_cvt_pk_bf16_f32 v188, v148, v149
    v_cvt_pk_bf16_f32 v189, v150, v151
    v_mfma_f32_16x16x32_bf16 v[68:71], v[40:43], a[192:195], 0
    buffer_load_dwordx4 a[40:43], v23, s[32:35], 0 offen offset:2048 sc1
    s_load_dword s51, s[14:15], 128
    v_mfma_f32_16x16x32_bf16 v[68:71], v[44:47], a[196:199], v[68:71]
    v_cvt_pk_bf16_f32 v190, v156, v157
    v_cvt_pk_bf16_f32 v191, v158, v159
    v_mfma_f32_16x16x32_bf16 v[68:71], v[48:51], a[200:203], v[68:71]
    buffer_load_dwordx4 a[44:47], v23, s[32:35], 0 offen offset:3072 sc1
    v_add_u32 v23, 4096, v23
    v_mfma_f32_16x16x32_bf16 v[72:75], v[40:43], a[204:207], 0
    v_cvt_pk_bf16_f32 v108, v64, v65
    v_cvt_pk_bf16_f32 v109, v66, v67
    v_mfma_f32_16x16x32_bf16 v[72:75], v[44:47], a[208:211], v[72:75]
    buffer_load_dwordx4 a[48:51], v23, s[32:35], 0 offen offset:0 sc1
    v_cvt_pk_bf16_f32 v192, v152, v153
    v_mfma_f32_16x16x32_bf16 v[72:75], v[48:51], a[212:215], v[72:75]
    v_cvt_pk_bf16_f32 v112, v68, v69
    v_cvt_pk_bf16_f32 v113, v70, v71
    v_mfma_f32_16x16x32_bf16 v[132:135], v[108:111], v[32:35], 0
L_pad1:
    s_cbranch_vccz L_ret1
    buffer_load_dwordx4 a[52:55], v23, s[32:35], 0 offen offset:1024 sc1
    v_cvt_pk_bf16_f32 v193, v154, v155
    v_mfma_f32_16x16x32_bf16 v[136:139], v[108:111], v[36:39], 0
    v_cvt_pk_bf16_f32 v194, v160, v161
    v_cvt_pk_bf16_f32 v195, v162, v163
    v_mfma_f32_16x16x32_bf16 v[140:143], v[112:115], v[32:35], 0
    buffer_load_dwordx4 a[56:59], v23, s[32:35], 0 offen offset:2048 sc1
    v_cvt_pk_bf16_f32 v116, v72, v73
    v_cvt_pk_bf16_f32 v117, v74, v75
    v_mfma_f32_16x16x32_bf16 v[144:147], v[112:115], v[36:39], 0
    v_cvt_pk_bf16_f32 v180, v132, v133
    v_cvt_pk_bf16_f32 v181, v134, v135
    v_mfma_f32_16x16x32_bf16 v[76:79], v[40:43], a[216:219], 0
    v_cvt_pk_bf16_f32 v184, v136, v137
    v_cvt_pk_bf16_f32 v185, v138, v139
    v_mfma_f32_16x16x32_bf16 v[76:79], v[44:47], a[220:223], v[76:79]
    v_cvt_pk_bf16_f32 v182, v140, v141
    v_cvt_pk_bf16_f32 v183, v142, v143
    v_mfma_f32_16x16x32_bf16 v[76:79], v[48:51], a[224:227], v[76:79]
    ds_write_b128 v11, v[180:183] offset:18480
    v_mfma_f32_16x16x32_bf16 v[80:83], v[40:43], a[228:231], 0
    v_cvt_pk_bf16_f32 v186, v144, v145
    v_cvt_pk_bf16_f32 v187, v146, v147
    v_mfma_f32_16x16x32_bf16 v[80:83], v[44:47], a[232:235], v[80:83]
    ds_write_b128 v11, v[184:187] offset:18736
    v_mfma_f32_16x16x32_bf16 v[80:83], v[48:51], a[236:239], v[80:83]
    s_nop 0
    v_cvt_pk_bf16_f32 v120, v76, v77
    v_cvt_pk_bf16_f32 v121, v78, v79
    v_mfma_f32_16x16x32_bf16 v[232:235], v[116:119], v[32:35], 0
    v_cvt_pk_bf16_f32 v196, v164, v165
    v_cvt_pk_bf16_f32 v197, v166, v167
    v_mfma_f32_16x16x32_bf16 v[236:239], v[116:119], v[36:39], 0
    v_cvt_pk_bf16_f32 v198, v172, v173
    v_cvt_pk_bf16_f32 v199, v174, v175
    v_mfma_f32_16x16x32_bf16 v[84:87], v[40:43], a[240:243], 0
    s_waitcnt lgkmcnt(0)
    s_barrier
    s_cmp_lt_u32 s51, 30
    s_cbranch_scc1 L_slow2
L_go2:
    v_cvt_pk_bf16_f32 v125, v82, v83
    v_mfma_f32_16x16x32_bf16 v[84:87], v[44:47], a[244:247], v[84:87]
    buffer_load_dwordx4 a[60:63], v23, s[32:35], 0 offen offset:3072 sc1
    ds_read_b128 a[176:179], v17 offset:0
    v_add_u32 v23, 4096, v23
    v_mfma_f32_16x16x32_bf16 v[84:87], v[48:51], a[248:251], v[84:87]
    ds_read_b128 a[180:183], v18 offset:0
    v_cvt_pk_bf16_f32 v124, v80, v81
    v_mfma_f32_16x16x32_bf16 v[240:243], v[120:123], v[32:35], 0
    buffer_load_dwordx4 a[64:67], v23, s[32:35], 0 offen offset:0 sc1
    ds_read_b128 a[184:187], v19 offset:0
    v_mfma_f32_16x16x32_bf16 v[244:247], v[120:123], v[36:39], 0
    ds_read_b128 a[188:191], v20 offset:0
    v_cvt_pk_bf16_f32 v200, v168, v169
    v_mfma_f32_16x16x32_bf16 v[248:251], v[124:127], v[32:35], 0
    buffer_load_dwordx4 a[68:71], v23, s[32:35], 0 offen offset:1024 sc1
    ds_read_b128 a[192:195], v21 offset:0
    v_cvt_pk_bf16_f32 v128, v84, v85
    v_cvt_pk_bf16_f32 v129, v86, v87
    v_mfma_f32_16x16x32_bf16 v[252:255], v[124:127], v[36:39], 0
    ds_read_b128 a[196:199], v22 offset:0
    v_cvt_pk_bf16_f32 v201, v170, v171
    v_mfma_f32_16x16x32_bf16 v[52:55], v[128:131], v[32:35], 0
    buffer_load_dwordx4 a[72:75], v23, s[32:35], 0 offen offset:2048 sc1
    ds_read_b128 a[168:171], v15 offset:0
    v_mfma_f32_16x16x32_bf16 v[56:59], v[128:131], v[36:39], 0
    ds_read_b128 a[172:175], v16 offset:0
    v_cvt_pk_bf16_f32 v202, v176, v177
    s_waitcnt vmcnt(18) lgkmcnt(7)
    v_mfma_f32_16x16x32_bf16 v[208:211], a[0:3], a[176:179], 0
    buffer_load_dwordx4 a[76:79], v23, s[32:35], 0 offen offset:3072 sc1
    v_add_u32 v23, 4096, v23
    s_waitcnt vmcnt(18) lgkmcnt(6)
    v_mfma_f32_16x16x32_bf16 v[208:211], a[4:7], a[180:183], v[208:211]
    v_cvt_pk_bf16_f32 v203, v178, v179
    s_waitcnt vmcnt(17) lgkmcnt(5)
    v_mfma_f32_16x16x32_bf16 v[208:211], a[8:11], a[184:187], v[208:211]
    buffer_load_dwordx4 a[80:83], v23, s[32:35], 0 offen offset:0 sc1
    s_waitcnt vmcnt(17) lgkmcnt(4)
    v_mfma_f32_16x16x32_bf16 v[208:211], a[12:15], a[188:191], v[208:211]
    ds_write_b128 v11, v[188:191] offset:14368
    s_waitcnt vmcnt(16) lgkmcnt(4)
    v_mfma_f32_16x16x32_bf16 v[208:211], a[16:19], a[192:195], v[208:211]
    s_waitcnt lgkmcnt(1)
    buffer_load_dwordx4 a[84:87], v23, s[32:35], 0 offen offset:1024 sc1
    v_mfma_f32_16x16x32_bf16 v[220:223], a[16:19], a[196:199], 0
    buffer_load_dwordx4 a[88:91], v23, s[32:35], 0 offen offset:2048 sc1
    v_mfma_f32_16x16x32_bf16 v[220:223], a[12:15], a[192:195], v[220:223]
    ds_write_b128 v11, v[192:195] offset:14624
    v_mfma_f32_16x16x32_bf16 v[220:223], a[8:11], a[188:191], v[220:223]
    buffer_load_dwordx4 a[92:95], v23, s[32:35], 0 offen offset:3072 sc1
    v_add_u32 v23, 4096, v23
    v_mfma_f32_16x16x32_bf16 v[220:223], a[4:7], a[184:187], v[220:223]
    buffer_load_dwordx4 a[96:99], v23, s[32:35], 0 offen offset:0 sc1
    v_cvt_pk_bf16_f32 v188, v232, v233
    v_mfma_f32_16x16x32_bf16 v[220:223], a[0:3], a[180:183], v[220:223]
    ds_write_b128 v11, v[196:199] offset:16416
    v_mfma_f32_16x16x32_bf16 v[64:67], a[0:3], a[168:171], 0
    v_cvt_pk_bf16_f32 v189, v234, v235
    v_cvt_pk_bf16_f32 v190, v240, v241
    v_mfma_f32_16x16x32_bf16 v[64:67], a[4:7], a[172:175], v[64:67]
    buffer_load_dwordx4 a[100:103], v23, s[32:35], 0 offen offset:1024 sc1
    v_cvt_pk_bf16_f32 v191, v242, v243
    v_mfma_f32_16x16x32_bf16 v[64:67], a[8:11], a[176:179], v[64:67]
    ds_write_b128 v11, v[200:203] offset:16672
    v_mfma_f32_16x16x32_bf16 v[64:67], a[12:15], a[180:183], v[64:67]
    v_cvt_pk_bf16_f32 v192, v236, v237
    v_cvt_pk_bf16_f32 v193, v238, v239
    v_mfma_f32_16x16x32_bf16 v[64:67], a[16:19], a[184:187], v[64:67]
    v_cvt_pk_bf16_f32 v194, v244, v245
    v_cvt_pk_bf16_f32 v195, v246, v247
    v_mfma_f32_16x16x32_bf16 v[76:79], a[16:19], a[188:191], 0
    ds_write_b128 v11, v[188:191] offset:20528
    v_mfma_f32_16x16x32_bf16 v[76:79], a[12:15], a[184:187], v[76:79]
    buffer_load_dwordx4 a[104:107], v23, s[32:35], 0 offen offset:2048 sc1
    v_cvt_pk_bf16_f32 v196, v248, v249
    v_mfma_f32_16x16x32_bf16 v[76:79], a[8:11], a[180:183], v[76:79]
    s_waitcnt vmcnt(17)
    v_cvt_pk_bf16_f32 v197, v250, v251
    v_cvt_pk_bf16_f32 v198, v52, v53
    v_mfma_f32_16x16x32_bf16 v[76:79], a[4:7], a[176:179], v[76:79]
    ds_write_b128 v11, v[192:195] offset:20784
    v_mfma_f32_16x16x32_bf16 v[76:79], a[0:3], a[172:175], v[76:79]
    buffer_load_dwordx4 a[108:111], v23, s[32:35], 0 offen offset:3072 sc1
    v_add_u32 v23, 4096, v23
    v_mfma_f32_16x16x32_bf16 v[80:83], a[20:23], a[172:175], 0
    v_cvt_pk_bf16_f32 v199, v54, v55
    v_cvt_pk_bf16_f32 v200, v252, v253
    v_mfma_f32_16x16x32_bf16 v[80:83], a[24:27], a[176:179], v[80:83]
    ds_write_b128 v11, v[196:199] offset:22576
    v_mfma_f32_16x16x32_bf16 v[80:83], a[28:31], a[180:183], v[80:83]
    buffer_load_dwordx4 a[112:115], v23, s[32:35], 0 offen offset:0 sc1
    v_cvt_pk_bf16_f32 v201, v254, v255
    v_mfma_f32_16x16x32_bf16 v[80:83], a[32:35], a[184:187], v[80:83]
    v_cvt_pk_bf16_f32 v202, v56, v57
    v_cvt_pk_bf16_f32 v203, v58, v59
    v_mfma_f32_16x16x32_bf16 v[80:83], a[36:39], a[188:191], v[80:83]
    ds_write_b128 v11, v[200:203] offset:22832
    v_mfma_f32_16x16x32_bf16 v[68:71], a[36:39], a[184:187], 0
    v_mfma_f32_16x16x32_bf16 v[68:71], a[32:35], a[180:183], v[68:71]
    buffer_load_dwordx4 a[116:119], v23, s[32:35], 0 offen offset:1024 sc1
    v_mfma_f32_16x16x32_bf16 v[68:71], a[28:31], a[176:179], v[68:71]
    v_mfma_f32_16x16x32_bf16 v[68:71], a[24:27], a[172:175], v[68:71]
    v_mfma_f32_16x16x32_bf16 v[68:71], a[20:23], a[168:171], v[68:71]
    s_waitcnt lgkmcnt(0)
    s_barrier
    v_mfma_f32_16x16x32_bf16 v[224:227], a[20:23], a[180:183], 0
    buffer_load_dwordx4 a[120:123], v23, s[32:35], 0 offen offset:2048 sc1
    ds_read_b128 a[208:211], v17 offset:2048
    v_mfma_f32_16x16x32_bf16 v[224:227], a[24:27], a[184:187], v[224:227]
    ds_read_b128 a[212:215], v18 offset:2048
    s_mul_i32 s63, s19, 9472
    v_mfma_f32_16x16x32_bf16 v[224:227], a[28:31], a[188:191], v[224:227]
    ds_read_b128 a[216:219], v19 offset:2048
    s_xor_b32 s62, s19, 2
    v_mfma_f32_16x16x32_bf16 v[224:227], a[32:35], a[192:195], v[224:227]
    ds_read_b128 a[220:223], v20 offset:2048
    s_mul_i32 s62, s62, 9472
    v_mfma_f32_16x16x32_bf16 v[224:227], a[36:39], a[196:199], v[224:227]
    buffer_load_dwordx4 a[124:127], v23, s[32:35], 0 offen offset:3072 sc1
    v_add_u32 v23, 4096, v23
    v_mfma_f32_16x16x32_bf16 v[212:215], a[36:39], a[192:195], 0
    ds_read_b128 a[224:227], v21 offset:2048
    s_mov_b32 s60, 172032
    v_mfma_f32_16x16x32_bf16 v[212:215], a[32:35], a[188:191], v[212:215]
    ds_read_b128 a[228:231], v22 offset:2048
    s_and_b32 s61, s19, 2
    v_mfma_f32_16x16x32_bf16 v[212:215], a[28:31], a[184:187], v[212:215]
    s_mul_i32 s61, s61, 9472
    s_lshl_b32 s59, s8, 1
    v_add_u32 v13, s63, v2
    v_mfma_f32_16x16x32_bf16 v[212:215], a[24:27], a[180:183], v[212:215]
    buffer_load_dwordx4 a[128:131], v23, s[32:35], 0 offen offset:0 sc1
    ds_read_b128 a[200:203], v15 offset:2048
    v_mfma_f32_16x16x32_bf16 v[212:215], a[20:23], a[176:179], v[212:215]
    s_waitcnt vmcnt(18)
    v_add_u32 v14, s62, v2
    v_lshl_add_u32 v37, v1, 2, s63
    v_mfma_f32_16x16x32_bf16 v[216:219], a[40:43], a[176:179], 0
    v_lshl_add_u32 v38, v1, 2, s62
    v_bfe_u32 v26, v1, 1, 2
    v_mfma_f32_16x16x32_bf16 v[216:219], a[44:47], a[180:183], v[216:219]
    buffer_load_dwordx4 a[132:135], v23, s[32:35], 0 offen offset:1024 sc1
    ds_read_b128 a[204:207], v16 offset:2048
    v_mfma_f32_16x16x32_bf16 v[216:219], a[48:51], a[184:187], v[216:219]
    v_xor_b32 v27, v25, v26
    v_lshlrev_b32 v28, 6, v24
    v_mfma_f32_16x16x32_bf16 v[216:219], a[52:55], a[188:191], v[216:219]
    v_lshl_add_u32 v27, v27, 4, v28
    v_add_u32 v4, s63, v27
    v_mfma_f32_16x16x32_bf16 v[216:219], a[56:59], a[192:195], v[216:219]
    v_lshrrev_b32 v27, 1, v25
    v_add_u32 v27, s59, v27
    v_mfma_f32_16x16x32_bf16 v[228:231], a[56:59], a[196:199], 0
    buffer_load_dwordx4 a[136:139], v23, s[32:35], 0 offen offset:2048 sc1
    v_xor_b32 v27, v27, v26
    v_mfma_f32_16x16x32_bf16 v[228:231], a[52:55], a[192:195], v[228:231]
    v_lshl_add_u32 v27, v27, 4, v28
    v_and_b32 v28, 1, v25
    v_mfma_f32_16x16x32_bf16 v[228:231], a[48:51], a[188:191], v[228:231]
    v_lshl_add_u32 v27, v28, 3, v27
    v_add_u32 v5, s61, v27
    v_mfma_f32_16x16x32_bf16 v[228:231], a[44:47], a[184:187], v[228:231]
    v_lshrrev_b32 v26, 3, v1
    v_xor_b32 v26, v26, v1
    v_mfma_f32_16x16x32_bf16 v[228:231], a[40:43], a[180:183], v[228:231]
    buffer_load_dwordx4 a[140:143], v23, s[32:35], 0 offen offset:3072 sc1
    v_add_u32 v23, 4096, v23
    v_mfma_f32_16x16x32_bf16 v[72:75], a[40:43], a[168:171], 0
    v_and_b32 v26, 3, v26
    v_lshlrev_b32 v26, 4, v26
    v_mfma_f32_16x16x32_bf16 v[72:75], a[44:47], a[172:175], v[72:75]
    v_mad_u32_u24 v26, v25, s60, v26
    v_bfe_u32 v27, v1, 2, 2
    v_mfma_f32_16x16x32_bf16 v[72:75], a[48:51], a[176:179], v[72:75]
    v_mul_u32_u24 v27, 768, v27
    v_add_u32 v26, v26, v27
    v_mfma_f32_16x16x32_bf16 v[72:75], a[52:55], a[180:183], v[72:75]
    buffer_load_dwordx4 a[144:147], v23, s[32:35], 0 offen offset:0 sc1
    s_mul_i32 s3, s10, 688128
    v_mfma_f32_16x16x32_bf16 v[72:75], a[56:59], a[184:187], v[72:75]
    s_mul_i32 s61, s11, 3072
    s_add_u32 s3, s3, s61
    s_xor_b32 s59, s8, s9
    v_mfma_f32_16x16x32_bf16 v[84:87], a[56:59], a[188:191], 0
    s_mul_i32 s59, s59, 43008
    s_add_u32 s59, s59, s3
    s_lshl_b32 s61, s8, 7
    v_mfma_f32_16x16x32_bf16 v[84:87], a[52:55], a[184:187], v[84:87]
    buffer_load_dwordx4 a[148:151], v23, s[32:35], 0 offen offset:1024 sc1
    s_add_u32 s3, s3, s61
    v_mfma_f32_16x16x32_bf16 v[84:87], a[48:51], a[180:183], v[84:87]
    s_mul_i32 s61, s9, 43008
    s_sub_u32 s60, 43008, s61
    s_add_u32 s61, s61, s3
    v_mfma_f32_16x16x32_bf16 v[84:87], a[44:47], a[176:179], v[84:87]
    s_add_u32 s60, s60, s3
    v_add_u32 v6, s61, v26
    v_add_u32 v7, s60, v26
    v_mfma_f32_16x16x32_bf16 v[84:87], a[40:43], a[172:175], v[84:87]
    s_waitcnt vmcnt(18) lgkmcnt(0)
    v_add_u32 v8, s59, v26
    v_mfma_f32_16x16x32_bf16 v[208:211], a[60:63], a[208:211], v[208:211]
    buffer_load_dwordx4 a[152:155], v23, s[32:35], 0 offen offset:2048 sc1
    s_cmp_eq_u32 s9, 0
    v_mfma_f32_16x16x32_bf16 v[208:211], a[64:67], a[212:215], v[208:211]
    s_mov_b32 s52, 0xbf800000
    s_cselect_b32 s52, 0x3f800000, s52
    s_mov_b32 s53, 0x3f000000
    v_mfma_f32_16x16x32_bf16 v[208:211], a[68:71], a[216:219], v[208:211]
    s_cselect_b32 s53, 0xbf000000, s53
    s_mov_b32 s54, 0xbdb60b61
    s_cselect_b32 s54, 0x3f360b61, s54
    v_mfma_f32_16x16x32_bf16 v[208:211], a[72:75], a[220:223], v[208:211]
    s_mov_b32 s55, 0x3eb60b61
    s_cselect_b32 s55, 0xbf360b61, s55
    s_mov_b32 s56, 0xbeb60b61
    v_mfma_f32_16x16x32_bf16 v[208:211], a[76:79], a[224:227], v[208:211]
    buffer_load_dwordx4 a[156:159], v23, s[32:35], 0 offen offset:3072 sc1
    v_add_u32 v23, 4096, v23
    v_mfma_f32_16x16x32_bf16 v[220:223], a[76:79], a[228:231], v[220:223]
    s_cselect_b32 s56, 0x3e360b61, s56
    s_mov_b32 s57, 0x3fb60b61
    s_cselect_b32 s57, 0xbe360b61, s57
    v_mfma_f32_16x16x32_bf16 v[220:223], a[72:75], a[224:227], v[220:223]
    s_mov_b32 s58, 0xbdb60b61
    s_cselect_b32 s58, 0x3c360b61, s58
    s_mov_b32 s59, 0x3db60b61
    v_mfma_f32_16x16x32_bf16 v[220:223], a[68:71], a[220:223], v[220:223]
    s_cselect_b32 s59, 0xbd360b61, s59
    s_mov_b32 s60, 0xbcb60b61
    s_cselect_b32 s60, 0x3d360b61, s60
    v_mfma_f32_16x16x32_bf16 v[220:223], a[64:67], a[216:219], v[220:223]
    buffer_load_dwordx4 a[160:163], v23, s[32:35], 0 offen offset:0 sc1
    s_mov_b32 s61, 0x3cb60b61
    v_mfma_f32_16x16x32_bf16 v[220:223], a[60:63], a[212:215], v[220:223]
    s_cselect_b32 s61, 0xbe360b61, s61
    s_mov_b32 s64, 86592
    s_cselect_b32 s64, 0, s64
    v_mfma_f32_16x16x32_bf16 v[64:67], a[60:63], a[200:203], v[64:67]
    s_mov_b32 s65, 86400
    s_cselect_b32 s65, 192, s65
    s_mov_b32 s66, 86208
    v_mfma_f32_16x16x32_bf16 v[64:67], a[64:67], a[204:207], v[64:67]
    s_cselect_b32 s66, 384, s66
    s_mov_b32 s67, 576
    s_cselect_b32 s67, 86016, s67
    v_mfma_f32_16x16x32_bf16 v[64:67], a[68:71], a[208:211], v[64:67]
    buffer_load_dwordx4 a[164:167], v23, s[32:35], 0 offen offset:1024 sc1
    v_mfma_f32_16x16x32_bf16 v[64:67], a[72:75], a[212:215], v[64:67]
    v_mfma_f32_16x16x32_bf16 v[64:67], a[76:79], a[216:219], v[64:67]
    v_mfma_f32_16x16x32_bf16 v[76:79], a[76:79], a[220:223], v[76:79]
    buffer_load_dwordx4 a[0:3], v23, s[32:35], 0 offen offset:2048 sc1
    v_mfma_f32_16x16x32_bf16 v[76:79], a[72:75], a[216:219], v[76:79]
    v_mfma_f32_16x16x32_bf16 v[76:79], a[68:71], a[212:215], v[76:79]
    v_mfma_f32_16x16x32_bf16 v[76:79], a[64:67], a[208:211], v[76:79]
    s_waitcnt vmcnt(18)
    v_mfma_f32_16x16x32_bf16 v[76:79], a[60:63], a[204:207], v[76:79]
    buffer_load_dwordx4 a[4:7], v23, s[32:35], 0 offen offset:3072 sc1
    v_add_u32 v23, 4096, v23
    v_mfma_f32_16x16x32_bf16 v[80:83], a[80:83], a[204:207], v[80:83]
    ds_read_b128 a[176:179], v17 offset:4096
    v_mfma_f32_16x16x32_bf16 v[80:83], a[84:87], a[208:211], v[80:83]
    v_mfma_f32_16x16x32_bf16 v[80:83], a[88:91], a[212:215], v[80:83]
    v_mfma_f32_16x16x32_bf16 v[80:83], a[92:95], a[216:219], v[80:83]
    buffer_load_dwordx4 a[8:11], v23, s[32:35], 0 offen offset:0 sc1
    ds_read_b128 a[180:183], v18 offset:4096
    v_mfma_f32_16x16x32_bf16 v[80:83], a[96:99], a[220:223], v[80:83]
    v_mfma_f32_16x16x32_bf16 v[68:71], a[96:99], a[216:219], v[68:71]
    v_mfma_f32_16x16x32_bf16 v[68:71], a[92:95], a[212:215], v[68:71]
    ds_read_b128 a[184:187], v19 offset:4096
    v_mfma_f32_16x16x32_bf16 v[68:71], a[88:91], a[208:211], v[68:71]
    buffer_load_dwordx4 a[12:15], v23, s[32:35], 0 offen offset:1024 sc1
    v_mfma_f32_16x16x32_bf16 v[68:71], a[84:87], a[204:207], v[68:71]
    v_mfma_f32_16x16x32_bf16 v[68:71], a[80:83], a[200:203], v[68:71]
    ds_read_b128 a[188:191], v20 offset:4096
    v_mfma_f32_16x16x32_bf16 v[224:227], a[80:83], a[212:215], v[224:227]
    v_mfma_f32_16x16x32_bf16 v[224:227], a[84:87], a[216:219], v[224:227]
    buffer_load_dwordx4 a[16:19], v23, s[32:35], 0 offen offset:2048 sc1
    v_mfma_f32_16x16x32_bf16 v[224:227], a[88:91], a[220:223], v[224:227]
    ds_read_b128 a[192:195], v21 offset:4096
    v_mfma_f32_16x16x32_bf16 v[224:227], a[92:95], a[224:227], v[224:227]
    v_mfma_f32_16x16x32_bf16 v[224:227], a[96:99], a[228:231], v[224:227]
    buffer_load_dwordx4 a[20:23], v23, s[32:35], 0 offen offset:3072 sc1
    v_add_u32 v23, 4096, v23
    v_mfma_f32_16x16x32_bf16 v[212:215], a[96:99], a[224:227], v[212:215]
    ds_read_b128 a[196:199], v22 offset:4096
    v_mfma_f32_16x16x32_bf16 v[212:215], a[92:95], a[220:223], v[212:215]
    v_mfma_f32_16x16x32_bf16 v[212:215], a[88:91], a[216:219], v[212:215]
    v_mfma_f32_16x16x32_bf16 v[212:215], a[84:87], a[212:215], v[212:215]
    buffer_load_dwordx4 a[24:27], v23, s[32:35], 0 offen offset:0 sc1
    ds_read_b128 a[168:171], v15 offset:4096
    v_mfma_f32_16x16x32_bf16 v[212:215], a[80:83], a[208:211], v[212:215]
    s_waitcnt vmcnt(19)
    v_mfma_f32_16x16x32_bf16 v[216:219], a[100:103], a[208:211], v[216:219]
    v_mfma_f32_16x16x32_bf16 v[216:219], a[104:107], a[212:215], v[216:219]
    ds_read_b128 a[172:175], v16 offset:4096
    v_mfma_f32_16x16x32_bf16 v[216:219], a[108:111], a[216:219], v[216:219]
    buffer_load_dwordx4 a[28:31], v23, s[32:35], 0 offen offset:1024 sc1
    v_mfma_f32_16x16x32_bf16 v[216:219], a[112:115], a[220:223], v[216:219]
    v_mfma_f32_16x16x32_bf16 v[216:219], a[116:119], a[224:227], v[216:219]
    v_mfma_f32_16x16x32_bf16 v[228:231], a[116:119], a[228:231], v[228:231]
    v_mfma_f32_16x16x32_bf16 v[228:231], a[112:115], a[224:227], v[228:231]
    buffer_load_dwordx4 a[32:35], v23, s[32:35], 0 offen offset:2048 sc1
    v_mfma_f32_16x16x32_bf16 v[228:231], a[108:111], a[220:223], v[228:231]
    v_mfma_f32_16x16x32_bf16 v[228:231], a[104:107], a[216:219], v[228:231]
    v_mfma_f32_16x16x32_bf16 v[228:231], a[100:103], a[212:215], v[228:231]
    v_mfma_f32_16x16x32_bf16 v[72:75], a[100:103], a[200:203], v[72:75]
    buffer_load_dwordx4 a[36:39], v23, s[32:35], 0 offen offset:3072 sc1
    v_add_u32 v23, 4096, v23
    v_mfma_f32_16x16x32_bf16 v[72:75], a[104:107], a[204:207], v[72:75]
    v_mfma_f32_16x16x32_bf16 v[72:75], a[108:111], a[208:211], v[72:75]
    v_mfma_f32_16x16x32_bf16 v[72:75], a[112:115], a[212:215], v[72:75]
    buffer_load_dwordx4 a[40:43], v23, s[32:35], 0 offen offset:0 sc1
    v_mfma_f32_16x16x32_bf16 v[72:75], a[116:119], a[216:219], v[72:75]
    v_mfma_f32_16x16x32_bf16 v[84:87], a[116:119], a[220:223], v[84:87]
    v_mfma_f32_16x16x32_bf16 v[84:87], a[112:115], a[216:219], v[84:87]
    v_mfma_f32_16x16x32_bf16 v[84:87], a[108:111], a[212:215], v[84:87]
    buffer_load_dwordx4 a[44:47], v23, s[32:35], 0 offen offset:1024 sc1
    v_mfma_f32_16x16x32_bf16 v[84:87], a[104:107], a[208:211], v[84:87]
    v_mfma_f32_16x16x32_bf16 v[84:87], a[100:103], a[204:207], v[84:87]
    s_waitcnt vmcnt(19) lgkmcnt(0)
    v_mfma_f32_16x16x32_bf16 v[208:211], a[120:123], a[176:179], v[208:211]
    v_mfma_f32_16x16x32_bf16 v[208:211], a[124:127], a[180:183], v[208:211]
    buffer_load_dwordx4 a[48:51], v23, s[32:35], 0 offen offset:2048 sc1
    v_mfma_f32_16x16x32_bf16 v[208:211], a[128:131], a[184:187], v[208:211]
    v_mfma_f32_16x16x32_bf16 v[208:211], a[132:135], a[188:191], v[208:211]
    v_mfma_f32_16x16x32_bf16 v[208:211], a[136:139], a[192:195], v[208:211]
    s_mov_b32 m0, s63
    v_mfma_f32_16x16x32_bf16 v[220:223], a[136:139], a[196:199], v[220:223]
    buffer_load_dwordx4 a[52:55], v23, s[32:35], 0 offen offset:3072 sc1
    v_add_u32 v23, 4096, v23
    v_mfma_f32_16x16x32_bf16 v[220:223], a[132:135], a[192:195], v[220:223]
    v_mfma_f32_16x16x32_bf16 v[220:223], a[128:131], a[188:191], v[220:223]
    v_mfma_f32_16x16x32_bf16 v[220:223], a[124:127], a[184:187], v[220:223]
    v_mfma_f32_16x16x32_bf16 v[220:223], a[120:123], a[180:183], v[220:223]
    buffer_load_dwordx4 a[56:59], v23, s[32:35], 0 offen offset:0 sc1
    v_mfma_f32_16x16x32_bf16 v[64:67], a[120:123], a[168:171], v[64:67]
    v_mfma_f32_16x16x32_bf16 v[64:67], a[124:127], a[172:175], v[64:67]
    ds_write_addtid_b32 v208 offset:3072
    v_mfma_f32_16x16x32_bf16 v[64:67], a[128:131], a[176:179], v[64:67]
    buffer_load_dwordx4 a[60:63], v23, s[32:35], 0 offen offset:1024 sc1
    ds_write_addtid_b32 v209 offset:3328
    v_mfma_f32_16x16x32_bf16 v[64:67], a[132:135], a[180:183], v[64:67]
    ds_write_addtid_b32 v210 offset:3584
    v_mfma_f32_16x16x32_bf16 v[64:67], a[136:139], a[184:187], v[64:67]
    ds_write_addtid_b32 v211 offset:3840
    v_mfma_f32_16x16x32_bf16 v[76:79], a[136:139], a[188:191], v[76:79]
    v_mfma_f32_16x16x32_bf16 v[76:79], a[132:135], a[184:187], v[76:79]
    buffer_load_dwordx4 a[64:67], v23, s[32:35], 0 offen offset:2048 sc1
    ds_write_addtid_b32 v220 offset:0
    v_mfma_f32_16x16x32_bf16 v[76:79], a[128:131], a[180:183], v[76:79]
    ds_write_addtid_b32 v221 offset:256
    v_mfma_f32_16x16x32_bf16 v[76:79], a[124:127], a[176:179], v[76:79]
    ds_write_addtid_b32 v222 offset:512
    v_mfma_f32_16x16x32_bf16 v[76:79], a[120:123], a[172:175], v[76:79]
    s_waitcnt vmcnt(19)
    v_mfma_f32_16x16x32_bf16 v[80:83], a[140:143], a[172:175], v[80:83]
    buffer_load_dwordx4 a[68:71], v23, s[32:35], 0 offen offset:3072 sc1
    v_add_u32 v23, 4096, v23
    v_mfma_f32_16x16x32_bf16 v[80:83], a[144:147], a[176:179], v[80:83]
    ds_read_b128 a[208:211], v17 offset:64
    v_mfma_f32_16x16x32_bf16 v[80:83], a[148:151], a[180:183], v[80:83]
    ds_write_addtid_b32 v223 offset:768
    v_mfma_f32_16x16x32_bf16 v[80:83], a[152:155], a[184:187], v[80:83]
    ds_read_b128 a[212:215], v18 offset:64
    v_mfma_f32_16x16x32_bf16 v[80:83], a[156:159], a[188:191], v[80:83]
    buffer_load_dwordx4 a[72:75], v23, s[32:35], 0 offen offset:0 sc1
    v_mfma_f32_16x16x32_bf16 v[68:71], a[156:159], a[184:187], v[68:71]
    v_mfma_f32_16x16x32_bf16 v[68:71], a[152:155], a[180:183], v[68:71]
    ds_read_b128 a[216:219], v19 offset:64
    v_mfma_f32_16x16x32_bf16 v[68:71], a[148:151], a[176:179], v[68:71]
    v_mfma_f32_16x16x32_bf16 v[68:71], a[144:147], a[172:175], v[68:71]
    buffer_load_dwordx4 a[76:79], v23, s[32:35], 0 offen offset:1024 sc1
    v_mfma_f32_16x16x32_bf16 v[68:71], a[140:143], a[168:171], v[68:71]
    ds_read_b128 a[220:223], v20 offset:64
    v_mfma_f32_16x16x32_bf16 v[224:227], a[140:143], a[180:183], v[224:227]
    v_mfma_f32_16x16x32_bf16 v[224:227], a[144:147], a[184:187], v[224:227]
    v_mfma_f32_16x16x32_bf16 v[224:227], a[148:151], a[188:191], v[224:227]
    buffer_load_dwordx4 a[80:83], v23, s[32:35], 0 offen offset:2048 sc1
    ds_read_b128 a[224:227], v21 offset:64
    v_mfma_f32_16x16x32_bf16 v[224:227], a[152:155], a[192:195], v[224:227]
    v_mfma_f32_16x16x32_bf16 v[224:227], a[156:159], a[196:199], v[224:227]
    v_mfma_f32_16x16x32_bf16 v[212:215], a[156:159], a[192:195], v[212:215]
    buffer_load_dwordx4 a[84:87], v23, s[32:35], 0 offen offset:3072 sc1
    v_add_u32 v23, 4096, v23
    v_mfma_f32_16x16x32_bf16 v[212:215], a[152:155], a[188:191], v[212:215]
    ds_read_b128 a[228:231], v22 offset:64
    v_mfma_f32_16x16x32_bf16 v[212:215], a[148:151], a[184:187], v[212:215]
    s_waitcnt vmcnt(19)
    v_mfma_f32_16x16x32_bf16 v[212:215], a[144:147], a[180:183], v[212:215]
    ds_read_b128 a[200:203], v15 offset:64
    v_mfma_f32_16x16x32_bf16 v[212:215], a[140:143], a[176:179], v[212:215]
    buffer_load_dwordx4 a[88:91], v23, s[32:35], 0 offen offset:0 sc1
    v_mfma_f32_16x16x32_bf16 v[216:219], a[160:163], a[176:179], v[216:219]
    v_mfma_f32_16x16x32_bf16 v[216:219], a[164:167], a[180:183], v[216:219]
    ds_read_b128 a[204:207], v16 offset:64
    v_mfma_f32_16x16x32_bf16 v[216:219], a[0:3], a[184:187], v[216:219]
    ds_write_addtid_b32 v224 offset:1024
    v_mfma_f32_16x16x32_bf16 v[216:219], a[4:7], a[188:191], v[216:219]
    buffer_load_dwordx4 a[92:95], v23, s[32:35], 0 offen offset:1024 sc1
    ds_write_addtid_b32 v225 offset:1280
    v_mfma_f32_16x16x32_bf16 v[216:219], a[8:11], a[192:195], v[216:219]
    ds_write_addtid_b32 v226 offset:1536
    v_mfma_f32_16x16x32_bf16 v[228:231], a[8:11], a[196:199], v[228:231]
    ds_write_addtid_b32 v227 offset:1792
    v_mfma_f32_16x16x32_bf16 v[228:231], a[4:7], a[192:195], v[228:231]
    ds_write_addtid_b32 v212 offset:4096
    v_mfma_f32_16x16x32_bf16 v[228:231], a[0:3], a[188:191], v[228:231]
    buffer_load_dwordx4 a[96:99], v23, s[32:35], 0 offen offset:2048 sc1
    ds_write_addtid_b32 v213 offset:4352
    v_mfma_f32_16x16x32_bf16 v[228:231], a[164:167], a[184:187], v[228:231]
    ds_write_addtid_b32 v214 offset:4608
    v_mfma_f32_16x16x32_bf16 v[228:231], a[160:163], a[180:183], v[228:231]
    ds_write_addtid_b32 v215 offset:4864
    v_mfma_f32_16x16x32_bf16 v[72:75], a[160:163], a[168:171], v[72:75]
    v_mfma_f32_16x16x32_bf16 v[72:75], a[164:167], a[172:175], v[72:75]
    buffer_load_dwordx4 a[100:103], v23, s[32:35], 0 offen offset:3072 sc1
    v_add_u32 v23, 4096, v23
    v_mfma_f32_16x16x32_bf16 v[72:75], a[0:3], a[176:179], v[72:75]
    ds_write_addtid_b32 v216 offset:5120
    v_mfma_f32_16x16x32_bf16 v[72:75], a[4:7], a[180:183], v[72:75]
    ds_write_addtid_b32 v217 offset:5376
    v_mfma_f32_16x16x32_bf16 v[72:75], a[8:11], a[184:187], v[72:75]
    buffer_load_dwordx4 a[104:107], v23, s[32:35], 0 offen offset:0 sc1
    ds_write_addtid_b32 v218 offset:5632
    v_mfma_f32_16x16x32_bf16 v[84:87], a[8:11], a[188:191], v[84:87]
    ds_write_addtid_b32 v219 offset:5888
    v_mfma_f32_16x16x32_bf16 v[84:87], a[4:7], a[184:187], v[84:87]
    ds_write_addtid_b32 v228 offset:2048
    v_mfma_f32_16x16x32_bf16 v[84:87], a[0:3], a[180:183], v[84:87]
    ds_write_addtid_b32 v229 offset:2304
    v_mfma_f32_16x16x32_bf16 v[84:87], a[164:167], a[176:179], v[84:87]
    buffer_load_dwordx4 a[108:111], v23, s[32:35], 0 offen offset:1024 sc1
    ds_write_addtid_b32 v230 offset:2560
    v_mfma_f32_16x16x32_bf16 v[84:87], a[160:163], a[172:175], v[84:87]
    s_waitcnt vmcnt(20) lgkmcnt(15)
    v_mfma_f32_16x16x32_bf16 v[208:211], a[12:15], a[208:211], 0
    ds_write_addtid_b32 v231 offset:2816
    v_mfma_f32_16x16x32_bf16 v[208:211], a[16:19], a[212:215], v[208:211]
    v_mfma_f32_16x16x32_bf16 v[208:211], a[20:23], a[216:219], v[208:211]
    buffer_load_dwordx4 a[112:115], v23, s[32:35], 0 offen offset:2048 sc1
    v_mfma_f32_16x16x32_bf16 v[208:211], a[24:27], a[220:223], v[208:211]
    v_mfma_f32_16x16x32_bf16 v[208:211], a[28:31], a[224:227], v[208:211]
    v_mfma_f32_16x16x32_bf16 v[220:223], a[28:31], a[228:231], 0
    v_mfma_f32_16x16x32_bf16 v[220:223], a[24:27], a[224:227], v[220:223]
    buffer_load_dwordx4 a[116:119], v23, s[32:35], 0 offen offset:3072 sc1
    v_add_u32 v23, 4096, v23
    v_mfma_f32_16x16x32_bf16 v[220:223], a[20:23], a[220:223], v[220:223]
    s_waitcnt lgkmcnt(0)
    s_barrier
    v_mfma_f32_16x16x32_bf16 v[220:223], a[16:19], a[216:219], v[220:223]
    ds_read2st64_b32 v[112:113], v38 offset0:0 offset1:1
    v_mfma_f32_16x16x32_bf16 v[220:223], a[12:15], a[212:215], v[220:223]
    ds_read2st64_b32 v[114:115], v38 offset0:2 offset1:3
    v_mfma_f32_16x16x32_bf16 v[88:91], a[12:15], a[200:203], 0
    buffer_load_dwordx4 a[120:123], v23, s[32:35], 0 offen offset:0 sc1
    ds_read2st64_b32 v[116:117], v38 offset0:4 offset1:5
    v_mfma_f32_16x16x32_bf16 v[88:91], a[16:19], a[204:207], v[88:91]
    ds_read2st64_b32 v[118:119], v38 offset0:6 offset1:7
    v_mfma_f32_16x16x32_bf16 v[88:91], a[20:23], a[208:211], v[88:91]
    ds_read2st64_b32 v[120:121], v38 offset0:8 offset1:9
    v_mfma_f32_16x16x32_bf16 v[88:91], a[24:27], a[212:215], v[88:91]
    ds_read2st64_b32 v[122:123], v38 offset0:10 offset1:11
    v_mfma_f32_16x16x32_bf16 v[88:91], a[28:31], a[216:219], v[88:91]
    buffer_load_dwordx4 a[124:127], v23, s[32:35], 0 offen offset:1024 sc1
    ds_read2st64_b32 v[124:125], v38 offset0:12 offset1:13
    v_mfma_f32_16x16x32_bf16 v[100:103], a[28:31], a[220:223], 0
    ds_read2st64_b32 v[126:127], v38 offset0:14 offset1:15
    v_mfma_f32_16x16x32_bf16 v[100:103], a[24:27], a[216:219], v[100:103]
    ds_read2st64_b32 v[128:129], v38 offset0:16 offset1:17
    v_mfma_f32_16x16x32_bf16 v[100:103], a[20:23], a[212:215], v[100:103]
    ds_read2st64_b32 v[130:131], v38 offset0:18 offset1:19
    v_mfma_f32_16x16x32_bf16 v[100:103], a[16:19], a[208:211], v[100:103]
    buffer_load_dwordx4 a[128:131], v23, s[32:35], 0 offen offset:2048 sc1
    ds_read2st64_b32 v[132:133], v38 offset0:20 offset1:21
    v_mfma_f32_16x16x32_bf16 v[100:103], a[12:15], a[204:207], v[100:103]
    s_waitcnt vmcnt(20)
    v_mfma_f32_16x16x32_bf16 v[104:107], a[32:35], a[204:207], 0
    ds_read_b128 a[176:179], v17 offset:2112
    s_waitcnt lgkmcnt(6)
    v_mfma_f32_16x16x32_bf16 v[104:107], a[36:39], a[208:211], v[104:107]
    ds_read2st64_b32 v[134:135], v38 offset0:22 offset1:23
    v_fma_f32 v136, s52, v64, v112
    v_mfma_f32_16x16x32_bf16 v[104:107], a[40:43], a[212:215], v[104:107]
    buffer_load_dwordx4 a[132:135], v23, s[32:35], 0 offen offset:3072 sc1
    v_add_u32 v23, 4096, v23
    v_mfma_f32_16x16x32_bf16 v[104:107], a[44:47], a[216:219], v[104:107]
    ds_read_b128 a[180:183], v18 offset:2112
    v_fma_f32 v160, -s52, v112, v64
    v_mfma_f32_16x16x32_bf16 v[104:107], a[48:51], a[220:223], v[104:107]
    v_fma_f32 v137, s52, v65, v113
    v_fma_f32 v161, -s52, v113, v65
    v_mfma_f32_16x16x32_bf16 v[92:95], a[48:51], a[216:219], 0
    v_fma_f32 v138, s52, v66, v114
    v_fma_f32 v162, -s52, v114, v66
    v_mfma_f32_16x16x32_bf16 v[92:95], a[44:47], a[212:215], v[92:95]
    buffer_load_dwordx4 a[136:139], v23, s[32:35], 0 offen offset:0 sc1
    ds_read_b128 a[184:187], v19 offset:2112
    v_mfma_f32_16x16x32_bf16 v[92:95], a[40:43], a[208:211], v[92:95]
    v_fma_f32 v139, s52, v67, v115
    v_fma_f32 v163, -s52, v115, v67
    v_mfma_f32_16x16x32_bf16 v[92:95], a[36:39], a[204:207], v[92:95]
L_pad2:
    s_cbranch_vccz L_ret2
    s_waitcnt lgkmcnt(2)
    v_fma_f32 v140, s52, v68, v116
    v_fma_f32 v164, -s52, v116, v68
    v_mfma_f32_16x16x32_bf16 v[92:95], a[32:35], a[200:203], v[92:95]
    ds_read_b128 a[188:191], v20 offset:2112
    v_fma_f32 v141, s52, v69, v117
    v_mfma_f32_16x16x32_bf16 v[224:227], a[32:35], a[212:215], 0
    buffer_load_dwordx4 a[140:143], v23, s[32:35], 0 offen offset:1024 sc1
    v_fma_f32 v165, -s52, v117, v69
    v_mfma_f32_16x16x32_bf16 v[224:227], a[36:39], a[216:219], v[224:227]
    v_fma_f32 v142, s52, v70, v118
    v_fma_f32 v166, -s52, v118, v70
    v_mfma_f32_16x16x32_bf16 v[224:227], a[40:43], a[220:223], v[224:227]
    ds_read_b128 a[192:195], v21 offset:2112
    v_fma_f32 v143, s52, v71, v119
    v_mfma_f32_16x16x32_bf16 v[224:227], a[44:47], a[224:227], v[224:227]
    v_fma_f32 v167, -s52, v119, v71
    v_fma_f32 v144, s52, v72, v120
    v_mfma_f32_16x16x32_bf16 v[224:227], a[48:51], a[228:231], v[224:227]
    buffer_load_dwordx4 a[144:147], v23, s[32:35], 0 offen offset:2048 sc1
    v_fma_f32 v168, -s52, v120, v72
    v_mfma_f32_16x16x32_bf16 v[212:215], a[48:51], a[224:227], 0
    ds_read_b128 a[196:199], v22 offset:2112
    v_fma_f32 v145, s52, v73, v121
    v_mfma_f32_16x16x32_bf16 v[212:215], a[44:47], a[220:223], v[212:215]
    v_fma_f32 v169, -s52, v121, v73
    v_fma_f32 v146, s52, v74, v122
    v_mfma_f32_16x16x32_bf16 v[212:215], a[40:43], a[216:219], v[212:215]
    s_waitcnt vmcnt(19)
    v_fma_f32 v170, -s52, v122, v74
    v_fma_f32 v147, s52, v75, v123
    v_mfma_f32_16x16x32_bf16 v[212:215], a[36:39], a[212:215], v[212:215]
    buffer_load_dwordx4 a[148:151], v23, s[32:35], 0 offen offset:3072 sc1
    v_add_u32 v23, 4096, v23
    v_mfma_f32_16x16x32_bf16 v[212:215], a[32:35], a[208:211], v[212:215]
    ds_read_b128 a[168:171], v15 offset:2112
    v_fma_f32 v171, -s52, v123, v75
    v_mfma_f32_16x16x32_bf16 v[216:219], a[52:55], a[208:211], 0
    v_fma_f32 v148, s52, v76, v124
    v_fma_f32 v172, -s52, v124, v76
    v_mfma_f32_16x16x32_bf16 v[216:219], a[56:59], a[212:215], v[216:219]
    ds_read_b128 a[172:175], v16 offset:2112
    v_fma_f32 v149, s52, v77, v125
    v_mfma_f32_16x16x32_bf16 v[216:219], a[60:63], a[216:219], v[216:219]
    buffer_load_dwordx4 a[152:155], v23, s[32:35], 0 offen offset:0 sc1
    v_fma_f32 v173, -s52, v125, v77
    v_mfma_f32_16x16x32_bf16 v[216:219], a[64:67], a[220:223], v[216:219]
    v_fma_f32 v150, s52, v78, v126
    v_fma_f32 v174, -s52, v126, v78
    v_mfma_f32_16x16x32_bf16 v[216:219], a[68:71], a[224:227], v[216:219]
    v_fma_f32 v151, s52, v79, v127
    v_fma_f32 v175, -s52, v127, v79
    v_mfma_f32_16x16x32_bf16 v[228:231], a[68:71], a[228:231], 0
    v_fma_f32 v152, s52, v80, v128
    v_fma_f32 v176, -s52, v128, v80
    v_mfma_f32_16x16x32_bf16 v[228:231], a[64:67], a[224:227], v[228:231]
    buffer_load_dwordx4 a[156:159], v23, s[32:35], 0 offen offset:1024 sc1
    v_fma_f32 v153, s52, v81, v129
    v_mfma_f32_16x16x32_bf16 v[228:231], a[60:63], a[220:223], v[228:231]
    v_fma_f32 v177, -s52, v129, v81
    v_fma_f32 v154, s52, v82, v130
    v_mfma_f32_16x16x32_bf16 v[228:231], a[56:59], a[216:219], v[228:231]
    v_fma_f32 v178, -s52, v130, v82
    v_fma_f32 v155, s52, v83, v131
    v_mfma_f32_16x16x32_bf16 v[228:231], a[52:55], a[212:215], v[228:231]
    v_fma_f32 v179, -s52, v131, v83
    v_fma_f32 v156, s52, v84, v132
    v_mfma_f32_16x16x32_bf16 v[96:99], a[52:55], a[200:203], 0
    buffer_load_dwordx4 a[160:163], v23, s[32:35], 0 offen offset:2048 sc1
    v_fma_f32 v180, -s52, v132, v84
    v_mfma_f32_16x16x32_bf16 v[96:99], a[56:59], a[204:207], v[96:99]
    v_fma_f32 v157, s52, v85, v133
    v_fma_f32 v181, -s52, v133, v85
    v_mfma_f32_16x16x32_bf16 v[96:99], a[60:63], a[208:211], v[96:99]
    v_fma_f32 v158, s52, v86, v134
    v_fma_f32 v182, -s52, v134, v86
    v_mfma_f32_16x16x32_bf16 v[96:99], a[64:67], a[212:215], v[96:99]
    v_fma_f32 v159, s52, v87, v135
    v_fma_f32 v183, -s52, v135, v87
    v_mfma_f32_16x16x32_bf16 v[96:99], a[68:71], a[216:219], v[96:99]
    buffer_load_dwordx4 a[164:167], v23, s[32:35], 0 offen offset:3072 sc1
    v_add_u32 v23, 4096, v23
    v_mfma_f32_16x16x32_bf16 v[108:111], a[68:71], a[220:223], 0
    v_mfma_f32_16x16x32_bf16 v[108:111], a[64:67], a[216:219], v[108:111]
    v_mfma_f32_16x16x32_bf16 v[108:111], a[60:63], a[212:215], v[108:111]
    v_mfma_f32_16x16x32_bf16 v[108:111], a[56:59], a[208:211], v[108:111]
    buffer_load_dwordx4 a[0:3], v23, s[32:35], 0 offen offset:0 sc1
    v_mfma_f32_16x16x32_bf16 v[108:111], a[52:55], a[204:207], v[108:111]
    s_waitcnt vmcnt(20) lgkmcnt(0)
    v_mfma_f32_16x16x32_bf16 v[208:211], a[72:75], a[176:179], v[208:211]
    v_mfma_f32_16x16x32_bf16 v[208:211], a[76:79], a[180:183], v[208:211]
    v_mfma_f32_16x16x32_bf16 v[208:211], a[80:83], a[184:187], v[208:211]
    buffer_load_dwordx4 a[4:7], v23, s[32:35], 0 offen offset:1024 sc1
    v_mfma_f32_16x16x32_bf16 v[208:211], a[84:87], a[188:191], v[208:211]
    v_mfma_f32_16x16x32_bf16 v[208:211], a[88:91], a[192:195], v[208:211]
    v_mfma_f32_16x16x32_bf16 v[220:223], a[88:91], a[196:199], v[220:223]
    v_mfma_f32_16x16x32_bf16 v[220:223], a[84:87], a[192:195], v[220:223]
    buffer_load_dwordx4 a[8:11], v23, s[32:35], 0 offen offset:2048 sc1
    v_mfma_f32_16x16x32_bf16 v[220:223], a[80:83], a[188:191], v[220:223]
    v_mfma_f32_16x16x32_bf16 v[220:223], a[76:79], a[184:187], v[220:223]
    v_mfma_f32_16x16x32_bf16 v[220:223], a[72:75], a[180:183], v[220:223]
    v_mfma_f32_16x16x32_bf16 v[88:91], a[72:75], a[168:171], v[88:91]
    buffer_load_dwordx4 a[12:15], v23, s[32:35], 0 offen offset:3072 sc1
    v_add_u32 v23, 4096, v23
    v_mfma_f32_16x16x32_bf16 v[88:91], a[76:79], a[172:175], v[88:91]
    v_mfma_f32_16x16x32_bf16 v[88:91], a[80:83], a[176:179], v[88:91]
    v_mfma_f32_16x16x32_bf16 v[88:91], a[84:87], a[180:183], v[88:91]
    v_mfma_f32_16x16x32_bf16 v[88:91], a[88:91], a[184:187], v[88:91]
    buffer_load_dwordx4 a[16:19], v23, s[32:35], 0 offen offset:0 sc1
    v_mfma_f32_16x16x32_bf16 v[100:103], a[88:91], a[188:191], v[100:103]
    v_mfma_f32_16x16x32_bf16 v[100:103], a[84:87], a[184:187], v[100:103]
    v_mfma_f32_16x16x32_bf16 v[100:103], a[80:83], a[180:183], v[100:103]
    v_mfma_f32_16x16x32_bf16 v[100:103], a[76:79], a[176:179], v[100:103]
    buffer_load_dwordx4 a[20:23], v23, s[32:35], 0 offen offset:1024 sc1
    v_mfma_f32_16x16x32_bf16 v[100:103], a[72:75], a[172:175], v[100:103]
    s_waitcnt vmcnt(20)
    v_mfma_f32_16x16x32_bf16 v[104:107], a[92:95], a[172:175], v[104:107]
    ds_read_b128 a[208:211], v17 offset:4160
    v_mfma_f32_16x16x32_bf16 v[104:107], a[96:99], a[176:179], v[104:107]
    buffer_load_dwordx4 a[24:27], v23, s[32:35], 0 offen offset:2048 sc1
    v_mfma_f32_16x16x32_bf16 v[104:107], a[100:103], a[180:183], v[104:107]
    v_mfma_f32_16x16x32_bf16 v[104:107], a[104:107], a[184:187], v[104:107]
    ds_read_b128 a[212:215], v18 offset:4160
    v_mfma_f32_16x16x32_bf16 v[104:107], a[108:111], a[188:191], v[104:107]
    v_mfma_f32_16x16x32_bf16 v[92:95], a[108:111], a[184:187], v[92:95]
    buffer_load_dwordx4 a[28:31], v23, s[32:35], 0 offen offset:3072 sc1
    v_add_u32 v23, 4096, v23
    v_mfma_f32_16x16x32_bf16 v[92:95], a[104:107], a[180:183], v[92:95]
    ds_read_b128 a[216:219], v19 offset:4160
    v_mfma_f32_16x16x32_bf16 v[92:95], a[100:103], a[176:179], v[92:95]
    v_mfma_f32_16x16x32_bf16 v[92:95], a[96:99], a[172:175], v[92:95]
    v_mfma_f32_16x16x32_bf16 v[92:95], a[92:95], a[168:171], v[92:95]
    buffer_load_dwordx4 a[32:35], v23, s[32:35], 0 offen offset:0 sc1
    ds_read_b128 a[220:223], v20 offset:4160
    v_mfma_f32_16x16x32_bf16 v[224:227], a[92:95], a[180:183], v[224:227]
    v_mfma_f32_16x16x32_bf16 v[224:227], a[96:99], a[184:187], v[224:227]
    v_mfma_f32_16x16x32_bf16 v[224:227], a[100:103], a[188:191], v[224:227]
    ds_read_b128 a[224:227], v21 offset:4160
    v_mfma_f32_16x16x32_bf16 v[224:227], a[104:107], a[192:195], v[224:227]
    buffer_load_dwordx4 a[36:39], v23, s[32:35], 0 offen offset:1024 sc1
    v_mfma_f32_16x16x32_bf16 v[224:227], a[108:111], a[196:199], v[224:227]
    v_mfma_f32_16x16x32_bf16 v[212:215], a[108:111], a[192:195], v[212:215]
    ds_read_b128 a[228:231], v22 offset:4160
    v_mfma_f32_16x16x32_bf16 v[212:215], a[104:107], a[188:191], v[212:215]
    v_mfma_f32_16x16x32_bf16 v[212:215], a[100:103], a[184:187], v[212:215]
    buffer_load_dwordx4 a[40:43], v23, s[32:35], 0 offen offset:2048 sc1
    v_mfma_f32_16x16x32_bf16 v[212:215], a[96:99], a[180:183], v[212:215]
    ds_read_b128 a[200:203], v15 offset:4160
    v_mfma_f32_16x16x32_bf16 v[212:215], a[92:95], a[176:179], v[212:215]
    s_waitcnt vmcnt(20)
    v_mfma_f32_16x16x32_bf16 v[216:219], a[112:115], a[176:179], v[216:219]
    v_mfma_f32_16x16x32_bf16 v[216:219], a[116:119], a[180:183], v[216:219]
    buffer_load_dwordx4 a[44:47], v23, s[32:35], 0 offen offset:3072 sc1
    v_add_u32 v23, 4096, v23
    v_mfma_f32_16x16x32_bf16 v[216:219], a[120:123], a[184:187], v[216:219]
    ds_read_b128 a[204:207], v16 offset:4160
    v_mfma_f32_16x16x32_bf16 v[216:219], a[124:127], a[188:191], v[216:219]
    v_mfma_f32_16x16x32_bf16 v[216:219], a[128:131], a[192:195], v[216:219]
    v_mfma_f32_16x16x32_bf16 v[228:231], a[128:131], a[196:199], v[228:231]
    buffer_load_dwordx4 a[48:51], v23, s[32:35], 0 offen offset:0 sc1
    v_mfma_f32_16x16x32_bf16 v[228:231], a[124:127], a[192:195], v[228:231]
    v_mfma_f32_16x16x32_bf16 v[228:231], a[120:123], a[188:191], v[228:231]
    v_mfma_f32_16x16x32_bf16 v[228:231], a[116:119], a[184:187], v[228:231]
    v_mfma_f32_16x16x32_bf16 v[228:231], a[112:115], a[180:183], v[228:231]
    buffer_load_dwordx4 a[52:55], v23, s[32:35], 0 offen offset:1024 sc1
    v_mfma_f32_16x16x32_bf16 v[96:99], a[112:115], a[168:171], v[96:99]
    v_mfma_f32_16x16x32_bf16 v[96:99], a[116:119], a[172:175], v[96:99]
    v_mfma_f32_16x16x32_bf16 v[96:99], a[120:123], a[176:179], v[96:99]
    v_mfma_f32_16x16x32_bf16 v[96:99], a[124:127], a[180:183], v[96:99]
    buffer_load_dwordx4 a[56:59], v23, s[32:35], 0 offen offset:2048 sc1
    v_mfma_f32_16x16x32_bf16 v[96:99], a[128:131], a[184:187], v[96:99]
    v_mfma_f32_16x16x32_bf16 v[108:111], a[128:131], a[188:191], v[108:111]
    v_mfma_f32_16x16x32_bf16 v[108:111], a[124:127], a[184:187], v[108:111]
    v_mfma_f32_16x16x32_bf16 v[108:111], a[120:123], a[180:183], v[108:111]
    buffer_load_dwordx4 a[60:63], v23, s[32:35], 0 offen offset:3072 sc1
    v_add_u32 v23, 4096, v23
    v_mfma_f32_16x16x32_bf16 v[108:111], a[116:119], a[176:179], v[108:111]
    v_mfma_f32_16x16x32_bf16 v[108:111], a[112:115], a[172:175], v[108:111]
    s_waitcnt vmcnt(20) lgkmcnt(0)
    v_mfma_f32_16x16x32_bf16 v[208:211], a[132:135], a[208:211], v[208:211]
    v_mfma_f32_16x16x32_bf16 v[208:211], a[136:139], a[212:215], v[208:211]
    buffer_load_dwordx4 a[64:67], v23, s[32:35], 0 offen offset:0 sc1
    v_mfma_f32_16x16x32_bf16 v[208:211], a[140:143], a[216:219], v[208:211]
    v_mfma_f32_16x16x32_bf16 v[208:211], a[144:147], a[220:223], v[208:211]
    v_mfma_f32_16x16x32_bf16 v[208:211], a[148:151], a[224:227], v[208:211]
    s_mov_b32 m0, s62
    v_mfma_f32_16x16x32_bf16 v[220:223], a[148:151], a[228:231], v[220:223]
    buffer_load_dwordx4 a[68:71], v23, s[32:35], 0 offen offset:1024 sc1
    v_mfma_f32_16x16x32_bf16 v[220:223], a[144:147], a[224:227], v[220:223]
    v_mfma_f32_16x16x32_bf16 v[220:223], a[140:143], a[220:223], v[220:223]
    v_mfma_f32_16x16x32_bf16 v[220:223], a[136:139], a[216:219], v[220:223]
    v_mfma_f32_16x16x32_bf16 v[220:223], a[132:135], a[212:215], v[220:223]
    buffer_load_dwordx4 a[72:75], v23, s[32:35], 0 offen offset:2048 sc1
    v_mfma_f32_16x16x32_bf16 v[88:91], a[132:135], a[200:203], v[88:91]
    v_mfma_f32_16x16x32_bf16 v[88:91], a[136:139], a[204:207], v[88:91]
    ds_write_addtid_b32 v208 offset:3072
    v_mfma_f32_16x16x32_bf16 v[88:91], a[140:143], a[208:211], v[88:91]
    ds_write_addtid_b32 v209 offset:3328
    v_mfma_f32_16x16x32_bf16 v[88:91], a[144:147], a[212:215], v[88:91]
    buffer_load_dwordx4 a[76:79], v23, s[32:35], 0 offen offset:3072 sc1
    v_add_u32 v23, 4096, v23
    v_mfma_f32_16x16x32_bf16 v[88:91], a[148:151], a[216:219], v[88:91]
    ds_write_addtid_b32 v210 offset:3584
    v_mfma_f32_16x16x32_bf16 v[100:103], a[148:151], a[220:223], v[100:103]
    ds_write_addtid_b32 v211 offset:3840
    v_mfma_f32_16x16x32_bf16 v[100:103], a[144:147], a[216:219], v[100:103]
    ds_write_addtid_b32 v220 offset:0
    v_mfma_f32_16x16x32_bf16 v[100:103], a[140:143], a[212:215], v[100:103]
    buffer_load_dwordx4 a[80:83], v23, s[32:35], 0 offen offset:0 sc1
    ds_write_addtid_b32 v221 offset:256
    v_mfma_f32_16x16x32_bf16 v[100:103], a[136:139], a[208:211], v[100:103]
    ds_write_addtid_b32 v222 offset:512
    v_mfma_f32_16x16x32_bf16 v[100:103], a[132:135], a[204:207], v[100:103]
    s_waitcnt vmcnt(20)
    v_mfma_f32_16x16x32_bf16 v[104:107], a[152:155], a[204:207], v[104:107]
    ds_read_b128 a[176:179], v17 offset:128
    v_mfma_f32_16x16x32_bf16 v[104:107], a[156:159], a[208:211], v[104:107]
    buffer_load_dwordx4 a[84:87], v23, s[32:35], 0 offen offset:1024 sc1
    ds_write_addtid_b32 v223 offset:768
    v_mfma_f32_16x16x32_bf16 v[104:107], a[160:163], a[212:215], v[104:107]
    v_mfma_f32_16x16x32_bf16 v[104:107], a[164:167], a[216:219], v[104:107]
    ds_read_b128 a[180:183], v18 offset:128
    v_mfma_f32_16x16x32_bf16 v[104:107], a[0:3], a[220:223], v[104:107]
    v_mfma_f32_16x16x32_bf16 v[92:95], a[0:3], a[216:219], v[92:95]
    buffer_load_dwordx4 a[88:91], v23, s[32:35], 0 offen offset:2048 sc1
    v_mfma_f32_16x16x32_bf16 v[92:95], a[164:167], a[212:215], v[92:95]
    ds_read_b128 a[184:187], v19 offset:128
    v_mfma_f32_16x16x32_bf16 v[92:95], a[160:163], a[208:211], v[92:95]
    v_mfma_f32_16x16x32_bf16 v[92:95], a[156:159], a[204:207], v[92:95]
    v_mfma_f32_16x16x32_bf16 v[92:95], a[152:155], a[200:203], v[92:95]
    buffer_load_dwordx4 a[92:95], v23, s[32:35], 0 offen offset:3072 sc1
    v_add_u32 v23, 4096, v23
    v_mfma_f32_16x16x32_bf16 v[224:227], a[152:155], a[212:215], v[224:227]
    ds_read_b128 a[188:191], v20 offset:128
    v_mfma_f32_16x16x32_bf16 v[224:227], a[156:159], a[216:219], v[224:227]
    v_mfma_f32_16x16x32_bf16 v[224:227], a[160:163], a[220:223], v[224:227]
    ds_read_b128 a[192:195], v21 offset:128
    v_mfma_f32_16x16x32_bf16 v[224:227], a[164:167], a[224:227], v[224:227]
    buffer_load_dwordx4 a[96:99], v23, s[32:35], 0 offen offset:0 sc1
    v_mfma_f32_16x16x32_bf16 v[224:227], a[0:3], a[228:231], v[224:227]
    v_mfma_f32_16x16x32_bf16 v[212:215], a[0:3], a[224:227], v[212:215]
    ds_read_b128 a[196:199], v22 offset:128
    v_mfma_f32_16x16x32_bf16 v[212:215], a[164:167], a[220:223], v[212:215]
    v_mfma_f32_16x16x32_bf16 v[212:215], a[160:163], a[216:219], v[212:215]
    buffer_load_dwordx4 a[100:103], v23, s[32:35], 0 offen offset:1024 sc1
    v_mfma_f32_16x16x32_bf16 v[212:215], a[156:159], a[212:215], v[212:215]
    ds_read_b128 a[168:171], v15 offset:128
    v_mfma_f32_16x16x32_bf16 v[212:215], a[152:155], a[208:211], v[212:215]
    s_waitcnt vmcnt(20)
    v_mfma_f32_16x16x32_bf16 v[216:219], a[4:7], a[208:211], v[216:219]
    v_mfma_f32_16x16x32_bf16 v[216:219], a[8:11], a[212:215], v[216:219]
    buffer_load_dwordx4 a[104:107], v23, s[32:35], 0 offen offset:2048 sc1
    ds_read_b128 a[172:175], v16 offset:128
    v_mfma_f32_16x16x32_bf16 v[216:219], a[12:15], a[216:219], v[216:219]
    ds_write_addtid_b32 v224 offset:1024
    v_mfma_f32_16x16x32_bf16 v[216:219], a[16:19], a[220:223], v[216:219]
    ds_write_addtid_b32 v225 offset:1280
    v_mfma_f32_16x16x32_bf16 v[216:219], a[20:23], a[224:227], v[216:219]
    ds_write_addtid_b32 v226 offset:1536
    v_mfma_f32_16x16x32_bf16 v[228:231], a[20:23], a[228:231], v[228:231]
    buffer_load_dwordx4 a[108:111], v23, s[32:35], 0 offen offset:3072 sc1
    v_add_u32 v23, 4096, v23
    v_mfma_f32_16x16x32_bf16 v[228:231], a[16:19], a[224:227], v[228:231]
    ds_write_addtid_b32 v227 offset:1792
    v_mfma_f32_16x16x32_bf16 v[228:231], a[12:15], a[220:223], v[228:231]
    ds_write_addtid_b32 v212 offset:4096
    v_mfma_f32_16x16x32_bf16 v[228:231], a[8:11], a[216:219], v[228:231]
    ds_write_addtid_b32 v213 offset:4352
    v_mfma_f32_16x16x32_bf16 v[228:231], a[4:7], a[212:215], v[228:231]
    buffer_load_dwordx4 a[112:115], v23, s[32:35], 0 offen offset:0 sc1
    ds_write_addtid_b32 v214 offset:4608
    v_mfma_f32_16x16x32_bf16 v[96:99], a[4:7], a[200:203], v[96:99]
    ds_write_addtid_b32 v215 offset:4864
    v_mfma_f32_16x16x32_bf16 v[96:99], a[8:11], a[204:207], v[96:99]
    ds_write_addtid_b32 v216 offset:5120
    v_mfma_f32_16x16x32_bf16 v[96:99], a[12:15], a[208:211], v[96:99]
    ds_write_addtid_b32 v217 offset:5376
    v_mfma_f32_16x16x32_bf16 v[96:99], a[16:19], a[212:215], v[96:99]
    buffer_load_dwordx4 a[116:119], v23, s[32:35], 0 offen offset:1024 sc1
    ds_write_addtid_b32 v218 offset:5632
    v_mfma_f32_16x16x32_bf16 v[96:99], a[20:23], a[216:219], v[96:99]
    ds_write_addtid_b32 v219 offset:5888
    v_mfma_f32_16x16x32_bf16 v[108:111], a[20:23], a[220:223], v[108:111]
    v_mfma_f32_16x16x32_bf16 v[108:111], a[16:19], a[216:219], v[108:111]
    ds_write_addtid_b32 v228 offset:2048
    v_mfma_f32_16x16x32_bf16 v[108:111], a[12:15], a[212:215], v[108:111]
    buffer_load_dwordx4 a[120:123], v23, s[32:35], 0 offen offset:2048 sc1
    ds_write_addtid_b32 v229 offset:2304
    v_mfma_f32_16x16x32_bf16 v[108:111], a[8:11], a[208:211], v[108:111]
    ds_write_addtid_b32 v230 offset:2560
    v_mfma_f32_16x16x32_bf16 v[108:111], a[4:7], a[204:207], v[108:111]
    s_waitcnt vmcnt(20) lgkmcnt(15)
    v_mfma_f32_16x16x32_bf16 a[232:235], a[24:27], a[176:179], 0
    ds_write_addtid_b32 v231 offset:2816
    v_mfma_f32_16x16x32_bf16 a[232:235], a[28:31], a[180:183], a[232:235]
    buffer_load_dwordx4 a[124:127], v23, s[32:35], 0 offen offset:3072 sc1
    v_add_u32 v23, 4096, v23
    v_mfma_f32_16x16x32_bf16 a[232:235], a[32:35], a[184:187], a[232:235]
    v_mfma_f32_16x16x32_bf16 a[232:235], a[36:39], a[188:191], a[232:235]
    v_mfma_f32_16x16x32_bf16 a[232:235], a[40:43], a[192:195], a[232:235]
    v_mfma_f32_16x16x32_bf16 a[244:247], a[40:43], a[196:199], 0
    buffer_load_dwordx4 a[128:131], v23, s[32:35], 0 offen offset:0 sc1
    v_mfma_f32_16x16x32_bf16 a[244:247], a[36:39], a[192:195], a[244:247]
    s_waitcnt lgkmcnt(0)
    s_barrier
    v_mfma_f32_16x16x32_bf16 a[244:247], a[32:35], a[188:191], a[244:247]
    ds_read2st64_b32 v[40:41], v37 offset0:0 offset1:1
    v_mfma_f32_16x16x32_bf16 a[244:247], a[28:31], a[184:187], a[244:247]
    ds_read2st64_b32 v[42:43], v37 offset0:2 offset1:3
    v_mfma_f32_16x16x32_bf16 a[244:247], a[24:27], a[180:183], a[244:247]
    buffer_load_dwordx4 a[132:135], v23, s[32:35], 0 offen offset:1024 sc1
    ds_read2st64_b32 v[44:45], v37 offset0:4 offset1:5
    v_mfma_f32_16x16x32_bf16 v[64:67], a[24:27], a[168:171], 0
    ds_read2st64_b32 v[46:47], v37 offset0:6 offset1:7
    v_mfma_f32_16x16x32_bf16 v[64:67], a[28:31], a[172:175], v[64:67]
    ds_read2st64_b32 v[48:49], v37 offset0:8 offset1:9
    v_mfma_f32_16x16x32_bf16 v[64:67], a[32:35], a[176:179], v[64:67]
    ds_read2st64_b32 v[50:51], v37 offset0:10 offset1:11
    v_mfma_f32_16x16x32_bf16 v[64:67], a[36:39], a[180:183], v[64:67]
    buffer_load_dwordx4 a[136:139], v23, s[32:35], 0 offen offset:2048 sc1
    ds_read2st64_b32 v[52:53], v37 offset0:12 offset1:13
    v_mfma_f32_16x16x32_bf16 v[64:67], a[40:43], a[184:187], v[64:67]
    ds_read2st64_b32 v[54:55], v37 offset0:14 offset1:15
    v_mfma_f32_16x16x32_bf16 v[76:79], a[40:43], a[188:191], 0
    ds_read2st64_b32 v[56:57], v37 offset0:16 offset1:17
    v_mfma_f32_16x16x32_bf16 v[76:79], a[36:39], a[184:187], v[76:79]
    ds_read2st64_b32 v[58:59], v37 offset0:18 offset1:19
    v_mfma_f32_16x16x32_bf16 v[76:79], a[32:35], a[180:183], v[76:79]
    buffer_load_dwordx4 a[140:143], v23, s[32:35], 0 offen offset:3072 sc1
    v_add_u32 v23, 4096, v23
    v_mfma_f32_16x16x32_bf16 v[76:79], a[28:31], a[176:179], v[76:79]
    ds_read2st64_b32 v[60:61], v37 offset0:20 offset1:21
    v_mfma_f32_16x16x32_bf16 v[76:79], a[24:27], a[172:175], v[76:79]
    s_waitcnt vmcnt(20)
    v_mfma_f32_16x16x32_bf16 v[80:83], a[44:47], a[172:175], 0
    buffer_load_dwordx4 a[144:147], v23, s[32:35], 0 offen offset:0 sc1
    ds_read_b128 a[204:207], v16 offset:2176
    v_mfma_f32_16x16x32_bf16 v[80:83], a[48:51], a[176:179], v[80:83]
    ds_read2st64_b32 v[62:63], v37 offset0:22 offset1:23
    s_waitcnt lgkmcnt(7)
    v_mfma_f32_16x16x32_bf16 v[80:83], a[52:55], a[180:183], v[80:83]
    v_fmac_f32 v88, s52, v40
    v_fmac_f32 v40, s53, v88
    v_mfma_f32_16x16x32_bf16 v[80:83], a[56:59], a[184:187], v[80:83]
    ds_read_b128 a[208:211], v17 offset:2176
    v_fma_f32 v184, s56, v88, v136
    v_mfma_f32_16x16x32_bf16 v[80:83], a[60:63], a[188:191], v[80:83]
    buffer_load_dwordx4 a[148:151], v23, s[32:35], 0 offen offset:1024 sc1
    v_fmac_f32 v136, s54, v88
    v_mfma_f32_16x16x32_bf16 v[68:71], a[60:63], a[184:187], 0
    v_fma_f32 v208, s57, v40, v160
    v_fmac_f32 v160, s55, v40
    v_mfma_f32_16x16x32_bf16 v[68:71], a[56:59], a[180:183], v[68:71]
    ds_read_b128 a[212:215], v18 offset:2176
    v_fmac_f32 v89, s52, v41
    v_mfma_f32_16x16x32_bf16 v[68:71], a[52:55], a[176:179], v[68:71]
    v_fmac_f32 v41, s53, v89
    v_fma_f32 v185, s56, v89, v137
    v_mfma_f32_16x16x32_bf16 v[68:71], a[48:51], a[172:175], v[68:71]
    buffer_load_dwordx4 a[152:155], v23, s[32:35], 0 offen offset:2048 sc1
    s_waitcnt lgkmcnt(2)
    v_mfma_f32_16x16x32_bf16 v[68:71], a[44:47], a[168:171], v[68:71]
    ds_read_b128 a[216:219], v19 offset:2176
    v_fmac_f32 v137, s54, v89
    v_mfma_f32_16x16x32_bf16 a[248:251], a[44:47], a[180:183], 0
    v_fma_f32 v209, s57, v41, v161
    v_fmac_f32 v161, s55, v41
    v_mfma_f32_16x16x32_bf16 a[248:251], a[48:51], a[184:187], a[248:251]
    v_fmac_f32 v90, s52, v42
    v_fmac_f32 v42, s53, v90
    v_mfma_f32_16x16x32_bf16 a[248:251], a[52:55], a[188:191], a[248:251]
    buffer_load_dwordx4 a[156:159], v23, s[32:35], 0 offen offset:3072 sc1
    v_add_u32 v23, 4096, v23
    v_mfma_f32_16x16x32_bf16 a[248:251], a[56:59], a[192:195], a[248:251]
    ds_read_b128 a[220:223], v20 offset:2176
    v_fma_f32 v186, s56, v90, v138
    v_mfma_f32_16x16x32_bf16 a[248:251], a[60:63], a[196:199], a[248:251]
    v_fmac_f32 v138, s54, v90
    v_fma_f32 v210, s57, v42, v162
    v_mfma_f32_16x16x32_bf16 a[236:239], a[60:63], a[192:195], 0
    ds_read_b128 a[200:203], v15 offset:2176
    v_fmac_f32 v162, s55, v42
    v_mfma_f32_16x16x32_bf16 a[236:239], a[56:59], a[188:191], a[236:239]
    buffer_load_dwordx4 a[160:163], v23, s[32:35], 0 offen offset:0 sc1
    v_fmac_f32 v91, s52, v43
    v_mfma_f32_16x16x32_bf16 a[236:239], a[52:55], a[184:187], a[236:239]
    v_fmac_f32 v43, s53, v91
    v_fma_f32 v187, s56, v91, v139
    v_mfma_f32_16x16x32_bf16 a[236:239], a[48:51], a[180:183], a[236:239]
    ds_read_b128 a[224:227], v21 offset:2176
    v_fmac_f32 v139, s54, v91
    v_mfma_f32_16x16x32_bf16 a[236:239], a[44:47], a[176:179], a[236:239]
    s_waitcnt vmcnt(20)
    v_fma_f32 v211, s57, v43, v163
    v_fmac_f32 v163, s55, v43
    v_mfma_f32_16x16x32_bf16 a[240:243], a[64:67], a[176:179], 0
    buffer_load_dwordx4 a[164:167], v23, s[32:35], 0 offen offset:1024 sc1
    v_fmac_f32 v92, s52, v44
    v_mfma_f32_16x16x32_bf16 a[240:243], a[68:71], a[180:183], a[240:243]
    ds_read_b128 a[228:231], v22 offset:2176
    v_fmac_f32 v44, s53, v92
    v_mfma_f32_16x16x32_bf16 a[240:243], a[72:75], a[184:187], a[240:243]
    v_fma_f32 v188, s56, v92, v140
    v_fmac_f32 v140, s54, v92
    v_mfma_f32_16x16x32_bf16 a[240:243], a[76:79], a[188:191], a[240:243]
    v_fma_f32 v212, s57, v44, v164
    v_fmac_f32 v164, s55, v44
    v_mfma_f32_16x16x32_bf16 a[240:243], a[80:83], a[192:195], a[240:243]
    buffer_load_dwordx4 a[0:3], v23, s[32:35], 0 offen offset:2048 sc1
    v_fmac_f32 v93, s52, v45
    v_mfma_f32_16x16x32_bf16 a[252:255], a[80:83], a[196:199], 0
    v_fmac_f32 v45, s53, v93
    v_fma_f32 v189, s56, v93, v141
    v_mfma_f32_16x16x32_bf16 a[252:255], a[76:79], a[192:195], a[252:255]
    v_fmac_f32 v141, s54, v93
    v_fma_f32 v213, s57, v45, v165
    v_mfma_f32_16x16x32_bf16 a[252:255], a[72:75], a[188:191], a[252:255]
    v_fmac_f32 v165, s55, v45
    v_fmac_f32 v94, s52, v46
    v_mfma_f32_16x16x32_bf16 a[252:255], a[68:71], a[184:187], a[252:255]
    buffer_load_dwordx4 a[4:7], v23, s[32:35], 0 offen offset:3072 sc1
    v_add_u32 v23, 4096, v23
    v_mfma_f32_16x16x32_bf16 a[252:255], a[64:67], a[180:183], a[252:255]
    v_fmac_f32 v46, s53, v94
    v_fma_f32 v190, s56, v94, v142
    v_mfma_f32_16x16x32_bf16 v[72:75], a[64:67], a[168:171], 0
    v_fmac_f32 v142, s54, v94
    v_fma_f32 v214, s57, v46, v166
    v_mfma_f32_16x16x32_bf16 v[72:75], a[68:71], a[172:175], v[72:75]
    buffer_load_dwordx4 a[8:11], v23, s[32:35], 0 offen offset:0 sc1
    v_fmac_f32 v166, s55, v46
    v_mfma_f32_16x16x32_bf16 v[72:75], a[72:75], a[176:179], v[72:75]
    v_fmac_f32 v95, s52, v47
    v_fmac_f32 v47, s53, v95
    v_mfma_f32_16x16x32_bf16 v[72:75], a[76:79], a[180:183], v[72:75]
    v_fma_f32 v191, s56, v95, v143
    v_fmac_f32 v143, s54, v95
    v_mfma_f32_16x16x32_bf16 v[72:75], a[80:83], a[184:187], v[72:75]
    v_fma_f32 v215, s57, v47, v167
    v_fmac_f32 v167, s55, v47
    v_mfma_f32_16x16x32_bf16 v[84:87], a[80:83], a[188:191], 0
    buffer_load_dwordx4 a[12:15], v23, s[32:35], 0 offen offset:1024 sc1
    v_fmac_f32 v96, s52, v48
    v_mfma_f32_16x16x32_bf16 v[84:87], a[76:79], a[184:187], v[84:87]
    v_fmac_f32 v48, s53, v96
    v_fma_f32 v192, s56, v96, v144
    v_mfma_f32_16x16x32_bf16 v[84:87], a[72:75], a[180:183], v[84:87]
    v_fmac_f32 v144, s54, v96
    v_fma_f32 v216, s57, v48, v168
    v_mfma_f32_16x16x32_bf16 v[84:87], a[68:71], a[176:179], v[84:87]
    s_waitcnt vmcnt(20) lgkmcnt(0)
    v_fmac_f32 v168, s55, v48
    v_fmac_f32 v97, s52, v49
    v_mfma_f32_16x16x32_bf16 v[84:87], a[64:67], a[172:175], v[84:87]
    buffer_load_dwordx4 a[16:19], v23, s[32:35], 0 offen offset:2048 sc1
    ds_read_b128 a[176:179], v17 offset:4224
    v_mfma_f32_16x16x32_bf16 v[76:79], a[84:87], a[204:207], v[76:79]
    ds_read_b128 a[180:183], v18 offset:4224
    v_fmac_f32 v49, s53, v97
    v_mfma_f32_16x16x32_bf16 v[76:79], a[88:91], a[208:211], v[76:79]
    ds_read_b128 a[184:187], v19 offset:4224
    v_fma_f32 v193, s56, v97, v145
    v_mfma_f32_16x16x32_bf16 v[76:79], a[92:95], a[212:215], v[76:79]
    ds_read_b128 a[188:191], v20 offset:4224
    v_fmac_f32 v145, s54, v97
    v_mfma_f32_16x16x32_bf16 v[76:79], a[96:99], a[216:219], v[76:79]
    buffer_load_dwordx4 a[20:23], v23, s[32:35], 0 offen offset:3072 sc1
    v_add_u32 v23, 4096, v23
    v_mfma_f32_16x16x32_bf16 v[76:79], a[100:103], a[220:223], v[76:79]
    ds_read_b128 a[192:195], v21 offset:4224
    v_fma_f32 v217, s57, v49, v169
    v_mfma_f32_16x16x32_bf16 v[64:67], a[100:103], a[216:219], v[64:67]
    ds_read_b128 a[196:199], v22 offset:4224
    v_fmac_f32 v169, s55, v49
    v_mfma_f32_16x16x32_bf16 v[64:67], a[96:99], a[212:215], v[64:67]
    ds_read_b128 a[168:171], v15 offset:4224
    v_fmac_f32 v98, s52, v50
    v_mfma_f32_16x16x32_bf16 v[64:67], a[92:95], a[208:211], v[64:67]
    buffer_load_dwordx4 a[24:27], v23, s[32:35], 0 offen offset:0 sc1
    ds_read_b128 a[172:175], v16 offset:4224
    v_mfma_f32_16x16x32_bf16 v[64:67], a[88:91], a[204:207], v[64:67]
    v_fmac_f32 v50, s53, v98
    v_fma_f32 v194, s56, v98, v146
    v_mfma_f32_16x16x32_bf16 v[64:67], a[84:87], a[200:203], v[64:67]
    v_fmac_f32 v146, s54, v98
    v_fma_f32 v218, s57, v50, v170
    v_mfma_f32_16x16x32_bf16 a[244:247], a[84:87], a[212:215], a[244:247]
    v_fmac_f32 v170, s55, v50
    v_fmac_f32 v99, s52, v51
    v_mfma_f32_16x16x32_bf16 a[244:247], a[88:91], a[216:219], a[244:247]
    buffer_load_dwordx4 a[28:31], v23, s[32:35], 0 offen offset:1024 sc1
    v_fmac_f32 v51, s53, v99
    v_mfma_f32_16x16x32_bf16 a[244:247], a[92:95], a[220:223], a[244:247]
    v_fma_f32 v195, s56, v99, v147
    v_fmac_f32 v147, s54, v99
    v_mfma_f32_16x16x32_bf16 a[244:247], a[96:99], a[224:227], a[244:247]
    v_fma_f32 v219, s57, v51, v171
    v_fmac_f32 v171, s55, v51
    v_mfma_f32_16x16x32_bf16 a[244:247], a[100:103], a[228:231], a[244:247]
    v_fmac_f32 v100, s52, v52
    v_fmac_f32 v52, s53, v100
    v_mfma_f32_16x16x32_bf16 a[232:235], a[100:103], a[224:227], a[232:235]
    buffer_load_dwordx4 a[32:35], v23, s[32:35], 0 offen offset:2048 sc1
    v_fma_f32 v196, s56, v100, v148
    v_mfma_f32_16x16x32_bf16 a[232:235], a[96:99], a[220:223], a[232:235]
    v_fmac_f32 v148, s54, v100
    v_fma_f32 v220, s57, v52, v172
    v_mfma_f32_16x16x32_bf16 a[232:235], a[92:95], a[216:219], a[232:235]
    v_fmac_f32 v172, s55, v52
    v_fmac_f32 v101, s52, v53
    v_mfma_f32_16x16x32_bf16 a[232:235], a[88:91], a[212:215], a[232:235]
    s_waitcnt vmcnt(20) lgkmcnt(0)
    v_fmac_f32 v53, s53, v101
    v_fma_f32 v197, s56, v101, v149
    v_mfma_f32_16x16x32_bf16 a[232:235], a[84:87], a[208:211], a[232:235]
    buffer_load_dwordx4 a[36:39], v23, s[32:35], 0 offen offset:3072 sc1
    v_add_u32 v23, 4096, v23
    v_mfma_f32_16x16x32_bf16 a[232:235], a[104:107], a[176:179], a[232:235]
    s_mov_b32 m0, s62
    v_fmac_f32 v149, s54, v101
    v_fma_f32 v221, s57, v53, v173
    v_mfma_f32_16x16x32_bf16 a[232:235], a[108:111], a[180:183], a[232:235]
    v_fmac_f32 v173, s55, v53
    v_fmac_f32 v102, s52, v54
    v_mfma_f32_16x16x32_bf16 a[232:235], a[112:115], a[184:187], a[232:235]
    buffer_load_dwordx4 a[40:43], v23, s[32:35], 0 offen offset:0 sc1
    v_fmac_f32 v54, s53, v102
    v_mfma_f32_16x16x32_bf16 a[232:235], a[116:119], a[188:191], a[232:235]
    v_fma_f32 v198, s56, v102, v150
    v_fmac_f32 v150, s54, v102
    v_mfma_f32_16x16x32_bf16 a[232:235], a[120:123], a[192:195], a[232:235]
    v_fma_f32 v222, s57, v54, v174
    v_fmac_f32 v174, s55, v54
    v_mfma_f32_16x16x32_bf16 a[244:247], a[120:123], a[196:199], a[244:247]
    v_fmac_f32 v103, s52, v55
    v_fmac_f32 v55, s53, v103
    v_mfma_f32_16x16x32_bf16 a[244:247], a[116:119], a[192:195], a[244:247]
    buffer_load_dwordx4 a[44:47], v23, s[32:35], 0 offen offset:1024 sc1
    v_fma_f32 v199, s56, v103, v151
    v_mfma_f32_16x16x32_bf16 a[244:247], a[112:115], a[188:191], a[244:247]
    v_fmac_f32 v151, s54, v103
    v_fma_f32 v223, s57, v55, v175
    v_mfma_f32_16x16x32_bf16 a[244:247], a[108:111], a[184:187], a[244:247]
    v_fmac_f32 v175, s55, v55
    v_fmac_f32 v104, s52, v56
    v_mfma_f32_16x16x32_bf16 a[244:247], a[104:107], a[180:183], a[244:247]
    v_fmac_f32 v56, s53, v104
    v_fma_f32 v200, s56, v104, v152
    v_mfma_f32_16x16x32_bf16 v[64:67], a[104:107], a[168:171], v[64:67]
    buffer_load_dwordx4 a[48:51], v23, s[32:35], 0 offen offset:2048 sc1
    v_fmac_f32 v152, s54, v104
    v_mfma_f32_16x16x32_bf16 v[64:67], a[108:111], a[172:175], v[64:67]
    ds_write_b64 v13, a[232:233] offset:3072
    v_mfma_f32_16x16x32_bf16 v[64:67], a[112:115], a[176:179], v[64:67]
L_pad3:
    s_cbranch_vccz L_ret3
    ds_write_b64 v13, a[234:235] offset:3080
    v_mfma_f32_16x16x32_bf16 v[64:67], a[116:119], a[180:183], v[64:67]
    v_fma_f32 v224, s57, v56, v176
    v_fmac_f32 v176, s55, v56
    v_mfma_f32_16x16x32_bf16 v[64:67], a[120:123], a[184:187], v[64:67]
    buffer_load_dwordx4 a[52:55], v23, s[32:35], 0 offen offset:3072 sc1
    v_add_u32 v23, 4096, v23
    v_mfma_f32_16x16x32_bf16 v[76:79], a[120:123], a[188:191], v[76:79]
    v_fmac_f32 v105, s52, v57
    v_fmac_f32 v57, s53, v105
    v_mfma_f32_16x16x32_bf16 v[76:79], a[116:119], a[184:187], v[76:79]
    ds_write_b64 v13, a[244:245] offset:0
    v_mfma_f32_16x16x32_bf16 v[76:79], a[112:115], a[180:183], v[76:79]
    ds_write_b64 v13, a[246:247] offset:8
    v_mfma_f32_16x16x32_bf16 v[76:79], a[108:111], a[176:179], v[76:79]
    buffer_load_dwordx4 a[56:59], v23, s[32:35], 0 offen offset:0 sc1
    v_fma_f32 v201, s56, v105, v153
    v_mfma_f32_16x16x32_bf16 v[76:79], a[104:107], a[172:175], v[76:79]
    s_waitcnt vmcnt(21)
    v_fmac_f32 v153, s54, v105
    v_fma_f32 v225, s57, v57, v177
    v_mfma_f32_16x16x32_bf16 v[80:83], a[124:127], a[204:207], v[80:83]
    v_fmac_f32 v177, s55, v57
    v_fmac_f32 v106, s52, v58
    v_mfma_f32_16x16x32_bf16 v[80:83], a[128:131], a[208:211], v[80:83]
    v_fmac_f32 v58, s53, v106
    v_fma_f32 v202, s56, v106, v154
    v_mfma_f32_16x16x32_bf16 v[80:83], a[132:135], a[212:215], v[80:83]
    buffer_load_dwordx4 a[60:63], v23, s[32:35], 0 offen offset:1024 sc1
    v_fmac_f32 v154, s54, v106
    v_mfma_f32_16x16x32_bf16 v[80:83], a[136:139], a[216:219], v[80:83]
    s_waitcnt lgkmcnt(0)
    s_barrier
    v_mfma_f32_16x16x32_bf16 v[80:83], a[140:143], a[220:223], v[80:83]
    ds_read_b128 v[112:115], v14 offset:0
    v_fma_f32 v226, s57, v58, v178
    v_mfma_f32_16x16x32_bf16 v[68:71], a[140:143], a[216:219], v[68:71]
    ds_read_b128 v[124:127], v14 offset:3072
    v_fmac_f32 v178, s55, v58
    v_mfma_f32_16x16x32_bf16 v[68:71], a[136:139], a[212:215], v[68:71]
    buffer_load_dwordx4 a[64:67], v23, s[32:35], 0 offen offset:2048 sc1
    v_fmac_f32 v107, s52, v59
    v_mfma_f32_16x16x32_bf16 v[68:71], a[132:135], a[208:211], v[68:71]
    v_fmac_f32 v59, s53, v107
    v_fma_f32 v203, s56, v107, v155
    v_mfma_f32_16x16x32_bf16 v[68:71], a[128:131], a[204:207], v[68:71]
    v_fmac_f32 v155, s54, v107
    v_fma_f32 v227, s57, v59, v179
    v_mfma_f32_16x16x32_bf16 v[68:71], a[124:127], a[200:203], v[68:71]
    v_fmac_f32 v179, s55, v59
    v_fmac_f32 v108, s52, v60
    v_mfma_f32_16x16x32_bf16 a[248:251], a[124:127], a[212:215], a[248:251]
    buffer_load_dwordx4 a[68:71], v23, s[32:35], 0 offen offset:3072 sc1
    v_add_u32 v23, 4096, v23
    v_mfma_f32_16x16x32_bf16 a[248:251], a[128:131], a[216:219], a[248:251]
    v_fmac_f32 v60, s53, v108
    v_fma_f32 v204, s56, v108, v156
    v_mfma_f32_16x16x32_bf16 a[248:251], a[132:135], a[220:223], a[248:251]
    s_waitcnt lgkmcnt(0)
    v_fmac_f32 v156, s54, v108
    v_fma_f32 v228, s57, v60, v180
    v_mfma_f32_16x16x32_bf16 a[248:251], a[136:139], a[224:227], a[248:251]
    v_fmac_f32 v180, s55, v60
    v_fmac_f32 v109, s52, v61
    v_mfma_f32_16x16x32_bf16 a[248:251], a[140:143], a[228:231], a[248:251]
    buffer_load_dwordx4 a[72:75], v23, s[32:35], 0 offen offset:0 sc1
    v_fmac_f32 v61, s53, v109
    v_mfma_f32_16x16x32_bf16 a[236:239], a[140:143], a[224:227], a[236:239]
    v_fma_f32 v205, s56, v109, v157
    v_fmac_f32 v157, s54, v109
    v_mfma_f32_16x16x32_bf16 a[236:239], a[136:139], a[220:223], a[236:239]
    v_fma_f32 v229, s57, v61, v181
    v_fmac_f32 v181, s55, v61
    v_mfma_f32_16x16x32_bf16 a[236:239], a[132:135], a[216:219], a[236:239]
    buffer_load_dwordx4 a[76:79], v23, s[32:35], 0 offen offset:1024 sc1
    v_fmac_f32 v110, s52, v62
    v_mfma_f32_16x16x32_bf16 a[236:239], a[128:131], a[212:215], a[236:239]
    v_fmac_f32 v62, s53, v110
    v_fma_f32 v206, s56, v110, v158
    v_mfma_f32_16x16x32_bf16 a[236:239], a[124:127], a[208:211], a[236:239]
    s_waitcnt vmcnt(21)
    v_fmac_f32 v158, s54, v110
    v_fma_f32 v230, s57, v62, v182
    v_mfma_f32_16x16x32_bf16 a[236:239], a[144:147], a[176:179], a[236:239]
    v_fmac_f32 v182, s55, v62
    v_fmac_f32 v111, s52, v63
    v_mfma_f32_16x16x32_bf16 a[236:239], a[148:151], a[180:183], a[236:239]
    buffer_load_dwordx4 a[80:83], v23, s[32:35], 0 offen offset:2048 sc1
    v_fmac_f32 v63, s53, v111
    v_mfma_f32_16x16x32_bf16 a[236:239], a[152:155], a[184:187], a[236:239]
    v_fma_f32 v207, s56, v111, v159
    v_fmac_f32 v159, s54, v111
    v_mfma_f32_16x16x32_bf16 a[236:239], a[156:159], a[188:191], a[236:239]
    v_fma_f32 v231, s57, v63, v183
    v_fmac_f32 v183, s55, v63
    v_mfma_f32_16x16x32_bf16 a[236:239], a[160:163], a[192:195], a[236:239]
    v_fmac_f32 v64, s52, v112
    v_fmac_f32 v184, s60, v64
    v_mfma_f32_16x16x32_bf16 a[248:251], a[160:163], a[196:199], a[248:251]
    buffer_load_dwordx4 a[84:87], v23, s[32:35], 0 offen offset:3072 sc1
    v_add_u32 v23, 4096, v23
    v_mfma_f32_16x16x32_bf16 a[248:251], a[156:159], a[192:195], a[248:251]
    v_fmac_f32 v65, s52, v113
    v_fmac_f32 v185, s60, v65
    v_mfma_f32_16x16x32_bf16 a[248:251], a[152:155], a[188:191], a[248:251]
    v_cvt_pk_bf16_f32 v24, v184, v185
    v_fmac_f32 v66, s52, v114
    v_mfma_f32_16x16x32_bf16 a[248:251], a[148:151], a[184:187], a[248:251]
    v_fmac_f32 v186, s60, v66
    v_fmac_f32 v67, s52, v115
    v_mfma_f32_16x16x32_bf16 a[248:251], a[144:147], a[180:183], a[248:251]
    buffer_load_dwordx4 a[88:91], v23, s[32:35], 0 offen offset:0 sc1
    v_fmac_f32 v187, s60, v67
    v_mfma_f32_16x16x32_bf16 v[68:71], a[144:147], a[168:171], v[68:71]
    v_cvt_pk_bf16_f32 v25, v186, v187
    v_fmac_f32 v76, s52, v124
    v_mfma_f32_16x16x32_bf16 v[68:71], a[148:151], a[172:175], v[68:71]
    ds_write_b64 v13, a[236:237] offset:4096
    v_mfma_f32_16x16x32_bf16 v[68:71], a[152:155], a[176:179], v[68:71]
    ds_write_b64 v13, a[238:239] offset:4104
    v_mfma_f32_16x16x32_bf16 v[68:71], a[156:159], a[180:183], v[68:71]
    buffer_load_dwordx4 a[92:95], v23, s[32:35], 0 offen offset:1024 sc1
    v_fmac_f32 v196, s60, v76
    v_mfma_f32_16x16x32_bf16 v[68:71], a[160:163], a[184:187], v[68:71]
    ds_write_b64 v5, v[24:25] offset:6144
    v_mfma_f32_16x16x32_bf16 v[80:83], a[160:163], a[188:191], v[80:83]
    v_fmac_f32 v77, s52, v125
    v_fmac_f32 v197, s60, v77
    v_mfma_f32_16x16x32_bf16 v[80:83], a[156:159], a[184:187], v[80:83]
    ds_write_b64 v13, a[248:249] offset:1024
    v_mfma_f32_16x16x32_bf16 v[80:83], a[152:155], a[180:183], v[80:83]
    ds_write_b64 v13, a[250:251] offset:1032
    v_mfma_f32_16x16x32_bf16 v[80:83], a[148:151], a[176:179], v[80:83]
    buffer_load_dwordx4 a[96:99], v23, s[32:35], 0 offen offset:2048 sc1
    v_cvt_pk_bf16_f32 v30, v196, v197
    v_mfma_f32_16x16x32_bf16 v[80:83], a[144:147], a[172:175], v[80:83]
    s_waitcnt vmcnt(21)
    v_fmac_f32 v78, s52, v126
    v_fmac_f32 v198, s60, v78
    v_mfma_f32_16x16x32_bf16 v[84:87], a[164:167], a[204:207], v[84:87]
    v_fmac_f32 v79, s52, v127
    v_fmac_f32 v199, s60, v79
    v_mfma_f32_16x16x32_bf16 v[84:87], a[0:3], a[208:211], v[84:87]
    buffer_load_dwordx4 a[100:103], v23, s[32:35], 0 offen offset:3072 sc1
    v_add_u32 v23, 4096, v23
    v_mfma_f32_16x16x32_bf16 v[84:87], a[4:7], a[212:215], v[84:87]
    v_cvt_pk_bf16_f32 v31, v198, v199
    v_fmac_f32 v112, s53, v64
    v_mfma_f32_16x16x32_bf16 v[84:87], a[8:11], a[216:219], v[84:87]
    s_waitcnt lgkmcnt(0)
    s_barrier
    v_mfma_f32_16x16x32_bf16 v[84:87], a[12:15], a[220:223], v[84:87]
    ds_read_b128 v[116:119], v14 offset:1024
    v_fmac_f32 v160, s59, v112
    v_mfma_f32_16x16x32_bf16 v[72:75], a[12:15], a[216:219], v[72:75]
    buffer_load_dwordx4 a[104:107], v23, s[32:35], 0 offen offset:0 sc1
    ds_read_b128 v[128:131], v14 offset:4096
    v_mfma_f32_16x16x32_bf16 v[72:75], a[8:11], a[212:215], v[72:75]
    ds_write_b64 v5, v[30:31] offset:15616
    v_mfma_f32_16x16x32_bf16 v[72:75], a[4:7], a[208:211], v[72:75]
    v_fmac_f32 v113, s53, v65
    v_fmac_f32 v161, s59, v113
    v_mfma_f32_16x16x32_bf16 v[72:75], a[0:3], a[204:207], v[72:75]
    buffer_load_dwordx4 a[108:111], v23, s[32:35], 0 offen offset:1024 sc1
    v_cvt_pk_bf16_f32 v232, v160, v161
    v_mfma_f32_16x16x32_bf16 v[72:75], a[164:167], a[200:203], v[72:75]
    v_fmac_f32 v114, s53, v66
    v_fmac_f32 v162, s59, v114
    v_mfma_f32_16x16x32_bf16 a[252:255], a[164:167], a[212:215], a[252:255]
    v_fmac_f32 v115, s53, v67
    v_fmac_f32 v163, s59, v115
    v_mfma_f32_16x16x32_bf16 a[252:255], a[0:3], a[216:219], a[252:255]
    v_cvt_pk_bf16_f32 v233, v162, v163
    v_fmac_f32 v124, s53, v76
    v_mfma_f32_16x16x32_bf16 a[252:255], a[4:7], a[220:223], a[252:255]
    s_waitcnt lgkmcnt(1)
    buffer_load_dwordx4 a[112:115], v23, s[32:35], 0 offen offset:2048 sc1
    v_mfma_f32_16x16x32_bf16 a[252:255], a[8:11], a[224:227], a[252:255]
    ds_write_b64 v5, v[232:233] offset:7168
    v_mfma_f32_16x16x32_bf16 a[252:255], a[12:15], a[228:231], a[252:255]
    v_fmac_f32 v172, s59, v124
    v_fmac_f32 v125, s53, v77
    v_mfma_f32_16x16x32_bf16 a[240:243], a[12:15], a[224:227], a[240:243]
    v_fmac_f32 v173, s59, v125
    v_cvt_pk_bf16_f32 v238, v172, v173
    v_mfma_f32_16x16x32_bf16 a[240:243], a[8:11], a[220:223], a[240:243]
    buffer_load_dwordx4 a[116:119], v23, s[32:35], 0 offen offset:3072 sc1
    v_add_u32 v23, 4096, v23
    v_mfma_f32_16x16x32_bf16 a[240:243], a[4:7], a[216:219], a[240:243]
    v_fmac_f32 v126, s53, v78
    v_fmac_f32 v174, s59, v126
    v_mfma_f32_16x16x32_bf16 a[240:243], a[0:3], a[212:215], a[240:243]
    s_waitcnt vmcnt(21)
    v_fmac_f32 v127, s53, v79
    v_fmac_f32 v175, s59, v127
    v_mfma_f32_16x16x32_bf16 a[240:243], a[164:167], a[208:211], a[240:243]
    ds_read_b128 a[208:211], v17 offset:192
    v_cvt_pk_bf16_f32 v239, v174, v175
    v_mfma_f32_16x16x32_bf16 a[240:243], a[16:19], a[176:179], a[240:243]
    buffer_load_dwordx4 a[120:123], v23, s[32:35], 0 offen offset:0 sc1
    ds_read_b128 a[212:215], v18 offset:192
    v_mfma_f32_16x16x32_bf16 a[240:243], a[20:23], a[180:183], a[240:243]
    ds_read_b128 a[216:219], v19 offset:192
    v_fmac_f32 v208, s61, v112
    v_mfma_f32_16x16x32_bf16 a[240:243], a[24:27], a[184:187], a[240:243]
    ds_read_b128 a[220:223], v20 offset:192
    v_fmac_f32 v209, s61, v113
    v_mfma_f32_16x16x32_bf16 a[240:243], a[28:31], a[188:191], a[240:243]
    ds_read_b128 a[224:227], v21 offset:192
    v_fmac_f32 v210, s61, v114
    v_mfma_f32_16x16x32_bf16 a[240:243], a[32:35], a[192:195], a[240:243]
    buffer_load_dwordx4 a[124:127], v23, s[32:35], 0 offen offset:1024 sc1
    ds_read_b128 a[228:231], v22 offset:192
    v_mfma_f32_16x16x32_bf16 a[252:255], a[32:35], a[196:199], a[252:255]
    ds_read_b128 a[200:203], v15 offset:192
    v_fmac_f32 v211, s61, v115
    v_mfma_f32_16x16x32_bf16 a[252:255], a[28:31], a[192:195], a[252:255]
    ds_read_b128 a[204:207], v16 offset:192
    v_fmac_f32 v220, s61, v124
    v_mfma_f32_16x16x32_bf16 a[252:255], a[24:27], a[188:191], a[252:255]
    ds_write_b64 v5, v[238:239] offset:16640
    v_mfma_f32_16x16x32_bf16 a[252:255], a[20:23], a[184:187], a[252:255]
    buffer_load_dwordx4 a[128:131], v23, s[32:35], 0 offen offset:2048 sc1
    ds_write_addtid_b32 v208 offset:3072
    v_mfma_f32_16x16x32_bf16 a[252:255], a[16:19], a[180:183], a[252:255]
    ds_write_addtid_b32 v209 offset:3328
    v_fmac_f32 v221, s61, v125
    v_mfma_f32_16x16x32_bf16 v[72:75], a[16:19], a[168:171], v[72:75]
    ds_write_addtid_b32 v210 offset:3584
    v_fmac_f32 v222, s61, v126
    v_mfma_f32_16x16x32_bf16 v[72:75], a[20:23], a[172:175], v[72:75]
    ds_write_b64 v13, a[240:241] offset:5120
    v_mfma_f32_16x16x32_bf16 v[72:75], a[24:27], a[176:179], v[72:75]
    ds_write_b64 v13, a[242:243] offset:5128
    v_mfma_f32_16x16x32_bf16 v[72:75], a[28:31], a[180:183], v[72:75]
    buffer_load_dwordx4 a[132:135], v23, s[32:35], 0 offen offset:3072 sc1
    v_add_u32 v23, 4096, v23
    v_mfma_f32_16x16x32_bf16 v[72:75], a[32:35], a[184:187], v[72:75]
    ds_write_addtid_b32 v211 offset:3840
    v_fmac_f32 v223, s61, v127
    v_mfma_f32_16x16x32_bf16 v[84:87], a[32:35], a[188:191], v[84:87]
    s_waitcnt lgkmcnt(7)
    v_fmac_f32 v68, s52, v116
    v_fmac_f32 v116, s53, v68
    v_mfma_f32_16x16x32_bf16 v[84:87], a[28:31], a[184:187], v[84:87]
    ds_write_b64 v13, a[252:253] offset:2048
    v_mfma_f32_16x16x32_bf16 v[84:87], a[24:27], a[180:183], v[84:87]
    ds_write_b64 v13, a[254:255] offset:2056
    v_mfma_f32_16x16x32_bf16 v[84:87], a[20:23], a[176:179], v[84:87]
    buffer_load_dwordx4 a[136:139], v23, s[32:35], 0 offen offset:0 sc1
    ds_write_addtid_b32 v220 offset:0
    v_mfma_f32_16x16x32_bf16 v[84:87], a[16:19], a[172:175], v[84:87]
    buffer_load_dwordx4 a[140:143], v23, s[32:35], 0 offen offset:1024 sc1
    s_waitcnt vmcnt(22)
    v_mfma_f32_16x16x32_bf16 v[88:91], a[36:39], a[208:211], 0
    ds_write_addtid_b32 v221 offset:256
    v_fmac_f32 v212, s61, v116
    v_mfma_f32_16x16x32_bf16 v[88:91], a[40:43], a[212:215], v[88:91]
    ds_write_addtid_b32 v222 offset:512
    v_fmac_f32 v69, s52, v117
    v_mfma_f32_16x16x32_bf16 v[88:91], a[44:47], a[216:219], v[88:91]
    ds_write_addtid_b32 v223 offset:768
    v_fmac_f32 v117, s53, v69
    v_mfma_f32_16x16x32_bf16 v[88:91], a[48:51], a[220:223], v[88:91]
    s_waitcnt lgkmcnt(4)
    s_barrier
    v_mfma_f32_16x16x32_bf16 v[88:91], a[52:55], a[224:227], v[88:91]
    buffer_load_dwordx4 a[144:147], v23, s[32:35], 0 offen offset:2048 sc1
    ds_read_b128 v[120:123], v14 offset:2048
    v_mfma_f32_16x16x32_bf16 v[100:103], a[52:55], a[228:231], 0
    ds_read_b128 v[132:135], v14 offset:5120
    v_fmac_f32 v213, s61, v117
    v_fmac_f32 v70, s52, v118
    v_mfma_f32_16x16x32_bf16 v[100:103], a[48:51], a[224:227], v[100:103]
    ds_write_addtid_b32 v212 offset:4096
    v_fmac_f32 v118, s53, v70
    v_mfma_f32_16x16x32_bf16 v[100:103], a[44:47], a[220:223], v[100:103]
    buffer_load_dwordx4 a[148:151], v23, s[32:35], 0 offen offset:3072 sc1
    v_add_u32 v23, 4096, v23
    v_mfma_f32_16x16x32_bf16 v[100:103], a[40:43], a[216:219], v[100:103]
    ds_write_addtid_b32 v213 offset:4352
    v_fmac_f32 v214, s61, v118
    v_mfma_f32_16x16x32_bf16 v[100:103], a[36:39], a[212:215], v[100:103]
    ds_write_addtid_b32 v214 offset:4608
    v_fmac_f32 v71, s52, v119
    v_mfma_f32_16x16x32_bf16 v[136:139], a[36:39], a[200:203], v[136:139]
    ds_read_b128 a[176:179], v17 offset:2240
    v_fmac_f32 v119, s53, v71
    v_mfma_f32_16x16x32_bf16 v[136:139], a[40:43], a[204:207], v[136:139]
    buffer_load_dwordx4 a[152:155], v23, s[32:35], 0 offen offset:0 sc1
    v_fmac_f32 v215, s61, v119
    v_mfma_f32_16x16x32_bf16 v[136:139], a[44:47], a[208:211], v[136:139]
    s_waitcnt lgkmcnt(4)
    ds_write_addtid_b32 v215 offset:4864
    v_mfma_f32_16x16x32_bf16 v[136:139], a[48:51], a[212:215], v[136:139]
    s_barrier
    v_mfma_f32_16x16x32_bf16 v[136:139], a[52:55], a[216:219], v[136:139]
    buffer_load_dwordx4 a[156:159], v23, s[32:35], 0 offen offset:1024 sc1
    ds_read_b128 v[184:187], v13 offset:6144
    v_mfma_f32_16x16x32_bf16 v[148:151], a[52:55], a[220:223], v[148:151]
    ds_read_b128 v[160:163], v13 offset:7168
    v_fmac_f32 v80, s52, v128
    v_mfma_f32_16x16x32_bf16 v[148:151], a[48:51], a[216:219], v[148:151]
    ds_read_b128 a[180:183], v18 offset:2240
    v_fmac_f32 v128, s53, v80
    v_mfma_f32_16x16x32_bf16 v[148:151], a[44:47], a[212:215], v[148:151]
    v_fmac_f32 v224, s61, v128
    v_fmac_f32 v81, s52, v129
    v_mfma_f32_16x16x32_bf16 v[148:151], a[40:43], a[208:211], v[148:151]
    buffer_load_dwordx4 a[160:163], v23, s[32:35], 0 offen offset:2048 sc1
    ds_read_b128 a[184:187], v19 offset:2240
    v_mfma_f32_16x16x32_bf16 v[148:151], a[36:39], a[204:207], v[148:151]
    s_waitcnt vmcnt(22)
    v_fmac_f32 v129, s53, v81
    v_fmac_f32 v225, s61, v129
    v_mfma_f32_16x16x32_bf16 v[152:155], a[56:59], a[204:207], v[152:155]
    ds_write_addtid_b32 v224 offset:1024
    v_fmac_f32 v82, s52, v130
    v_mfma_f32_16x16x32_bf16 v[152:155], a[60:63], a[208:211], v[152:155]
    buffer_load_dwordx4 a[164:167], v23, s[32:35], 0 offen offset:3072 sc1
    v_add_u32 v23, 4096, v23
    v_mfma_f32_16x16x32_bf16 v[152:155], a[64:67], a[212:215], v[152:155]
    ds_read_b128 a[188:191], v20 offset:2240
    s_waitcnt lgkmcnt(5)
    v_mfma_f32_16x16x32_bf16 v[152:155], a[68:71], a[216:219], v[152:155]
    ds_write_addtid_b32 v225 offset:1280
    s_waitcnt lgkmcnt(5)
    v_mfma_f32_16x16x32_bf16 v[152:155], a[72:75], a[220:223], v[152:155]
    v_fmac_f32 v130, s53, v82
    v_fmac_f32 v226, s61, v130
    v_mfma_f32_16x16x32_bf16 v[140:143], a[72:75], a[216:219], v[140:143]
    buffer_load_dwordx4 a[0:3], v23, s[32:35], 0 offen offset:0 sc1
    ds_write_addtid_b32 v226 offset:1536
    v_mfma_f32_16x16x32_bf16 v[140:143], a[68:71], a[212:215], v[140:143]
    ds_read_b128 a[192:195], v21 offset:2240
    v_fmac_f32 v83, s52, v131
    v_mfma_f32_16x16x32_bf16 v[140:143], a[64:67], a[208:211], v[140:143]
    v_fmac_f32 v131, s53, v83
    v_fmac_f32 v227, s61, v131
    v_mfma_f32_16x16x32_bf16 v[140:143], a[60:63], a[204:207], v[140:143]
    ds_write_addtid_b32 v227 offset:1792
    v_fmac_f32 v72, s52, v120
    v_mfma_f32_16x16x32_bf16 v[140:143], a[56:59], a[200:203], v[140:143]
    buffer_load_dwordx4 a[4:7], v23, s[32:35], 0 offen offset:1024 sc1
    v_fmac_f32 v120, s53, v72
    v_mfma_f32_16x16x32_bf16 v[104:107], a[56:59], a[212:215], 0
    ds_read_b128 a[196:199], v22 offset:2240
    v_fmac_f32 v216, s61, v120
    v_mfma_f32_16x16x32_bf16 v[104:107], a[60:63], a[216:219], v[104:107]
    ds_write_addtid_b32 v216 offset:5120
    v_fmac_f32 v73, s52, v121
    v_mfma_f32_16x16x32_bf16 v[104:107], a[64:67], a[220:223], v[104:107]
    buffer_load_dwordx4 a[8:11], v23, s[32:35], 0 offen offset:2048 sc1
    v_fmac_f32 v121, s53, v73
    v_mfma_f32_16x16x32_bf16 v[104:107], a[68:71], a[224:227], v[104:107]
    v_fmac_f32 v217, s61, v121
    v_fmac_f32 v74, s52, v122
    v_mfma_f32_16x16x32_bf16 v[104:107], a[72:75], a[228:231], v[104:107]
    ds_read_b128 a[168:171], v15 offset:2240
    v_fmac_f32 v122, s53, v74
    v_mfma_f32_16x16x32_bf16 v[92:95], a[72:75], a[224:227], 0
    ds_write_addtid_b32 v217 offset:5376
    v_fmac_f32 v218, s61, v122
    v_mfma_f32_16x16x32_bf16 v[92:95], a[68:71], a[220:223], v[92:95]
    buffer_load_dwordx4 a[12:15], v23, s[32:35], 0 offen offset:3072 sc1
    v_add_u32 v23, 4096, v23
    v_mfma_f32_16x16x32_bf16 v[92:95], a[64:67], a[216:219], v[92:95]
    ds_write_addtid_b32 v218 offset:5632
    v_fmac_f32 v75, s52, v123
    v_mfma_f32_16x16x32_bf16 v[92:95], a[60:63], a[212:215], v[92:95]
    s_waitcnt vmcnt(22)
    v_fmac_f32 v123, s53, v75
    v_fmac_f32 v219, s61, v123
    v_mfma_f32_16x16x32_bf16 v[92:95], a[56:59], a[208:211], v[92:95]
    buffer_load_dwordx4 a[16:19], v23, s[32:35], 0 offen offset:0 sc1
    ds_read_b128 a[172:175], v16 offset:2240
    v_mfma_f32_16x16x32_bf16 v[96:99], a[76:79], a[208:211], 0
    ds_write_addtid_b32 v219 offset:5888
    v_fmac_f32 v84, s52, v132
    v_mfma_f32_16x16x32_bf16 v[96:99], a[80:83], a[212:215], v[96:99]
    v_fmac_f32 v132, s53, v84
    v_fmac_f32 v228, s61, v132
    v_mfma_f32_16x16x32_bf16 v[96:99], a[84:87], a[216:219], v[96:99]
    ds_write_addtid_b32 v228 offset:2048
    v_fmac_f32 v85, s52, v133
    v_mfma_f32_16x16x32_bf16 v[96:99], a[88:91], a[220:223], v[96:99]
    buffer_load_dwordx4 a[20:23], v23, s[32:35], 0 offen offset:1024 sc1
    v_fmac_f32 v133, s53, v85
    v_mfma_f32_16x16x32_bf16 v[96:99], a[92:95], a[224:227], v[96:99]
    v_fmac_f32 v229, s61, v133
    v_fmac_f32 v86, s52, v134
    v_mfma_f32_16x16x32_bf16 v[108:111], a[92:95], a[228:231], 0
    ds_write_addtid_b32 v229 offset:2304
    v_fmac_f32 v134, s53, v86
    v_mfma_f32_16x16x32_bf16 v[108:111], a[88:91], a[224:227], v[108:111]
    v_fmac_f32 v230, s61, v134
    v_fmac_f32 v87, s52, v135
    v_mfma_f32_16x16x32_bf16 v[108:111], a[84:87], a[220:223], v[108:111]
    buffer_load_dwordx4 a[24:27], v23, s[32:35], 0 offen offset:2048 sc1
    ds_write_addtid_b32 v230 offset:2560
    v_mfma_f32_16x16x32_bf16 v[108:111], a[80:83], a[216:219], v[108:111]
    v_fmac_f32 v135, s53, v87
    v_fmac_f32 v231, s61, v135
    v_mfma_f32_16x16x32_bf16 v[108:111], a[76:79], a[212:215], v[108:111]
    ds_write_addtid_b32 v231 offset:2816
    v_fmac_f32 v188, s60, v68
    v_mfma_f32_16x16x32_bf16 v[144:147], a[76:79], a[200:203], v[144:147]
    buffer_load_dwordx4 a[28:31], v23, s[32:35], 0 offen offset:3072 sc1
    v_add_u32 v23, 4096, v23
    v_mfma_f32_16x16x32_bf16 v[144:147], a[80:83], a[204:207], v[144:147]
    v_fmac_f32 v189, s60, v69
    v_cvt_pk_bf16_f32 v26, v188, v189
    v_mfma_f32_16x16x32_bf16 v[144:147], a[84:87], a[208:211], v[144:147]
    v_fmac_f32 v190, s60, v70
    v_fmac_f32 v191, s60, v71
    v_mfma_f32_16x16x32_bf16 v[144:147], a[88:91], a[212:215], v[144:147]
    v_cvt_pk_bf16_f32 v27, v190, v191
    v_fmac_f32 v200, s60, v80
    v_mfma_f32_16x16x32_bf16 v[144:147], a[92:95], a[216:219], v[144:147]
    buffer_load_dwordx4 a[32:35], v23, s[32:35], 0 offen offset:0 sc1
    v_fmac_f32 v201, s60, v81
    v_mfma_f32_16x16x32_bf16 v[156:159], a[92:95], a[220:223], v[156:159]
    ds_write_b64 v4, v[26:27] offset:8192
    v_mfma_f32_16x16x32_bf16 v[156:159], a[88:91], a[216:219], v[156:159]
    s_waitcnt lgkmcnt(1)
    s_barrier
    v_mfma_f32_16x16x32_bf16 v[156:159], a[84:87], a[212:215], v[156:159]
    buffer_load_dwordx4 a[36:39], v23, s[32:35], 0 offen offset:1024 sc1
    ds_read2st64_b32 v[40:41], v37 offset0:0 offset1:1
    v_mfma_f32_16x16x32_bf16 v[156:159], a[80:83], a[208:211], v[156:159]
    ds_read_b128 a[208:211], v17 offset:4288
    v_mfma_f32_16x16x32_bf16 v[156:159], a[76:79], a[204:207], v[156:159]
    s_waitcnt vmcnt(23)
    v_cvt_pk_bf16_f32 v32, v200, v201
    v_fmac_f32 v202, s60, v82
    v_mfma_f32_16x16x32_bf16 v[88:91], a[96:99], a[176:179], v[88:91]
    ds_read_b128 a[212:215], v18 offset:4288
    v_fmac_f32 v203, s60, v83
    v_mfma_f32_16x16x32_bf16 v[88:91], a[100:103], a[180:183], v[88:91]
    buffer_load_dwordx4 a[40:43], v23, s[32:35], 0 offen offset:2048 sc1
    ds_read_b128 a[216:219], v19 offset:4288
    v_mfma_f32_16x16x32_bf16 v[88:91], a[104:107], a[184:187], v[88:91]
    ds_read_b128 a[220:223], v20 offset:4288
    v_cvt_pk_bf16_f32 v33, v202, v203
    v_mfma_f32_16x16x32_bf16 v[88:91], a[108:111], a[188:191], v[88:91]
    ds_read_b128 a[224:227], v21 offset:4288
    v_fmac_f32 v192, s60, v72
    v_mfma_f32_16x16x32_bf16 v[88:91], a[112:115], a[192:195], v[88:91]
    ds_read_b128 a[228:231], v22 offset:4288
    v_fmac_f32 v193, s60, v73
    v_mfma_f32_16x16x32_bf16 v[100:103], a[112:115], a[196:199], v[100:103]
    buffer_load_dwordx4 a[44:47], v23, s[32:35], 0 offen offset:3072 sc1
    ds_read_b128 a[200:203], v15 offset:4288
    v_mfma_f32_16x16x32_bf16 v[100:103], a[108:111], a[192:195], v[100:103]
    buffer_store_dwordx4 v[184:187], v8, s[36:39], s66 offen offset:64 sc0 sc1
    v_mfma_f32_16x16x32_bf16 v[100:103], a[104:107], a[188:191], v[100:103]
    ds_read_b128 a[204:207], v16 offset:4288
    v_cvt_pk_bf16_f32 v28, v192, v193
    v_mfma_f32_16x16x32_bf16 v[100:103], a[100:103], a[184:187], v[100:103]
    ds_read2st64_b32 v[42:43], v37 offset0:2 offset1:3
    v_fmac_f32 v194, s60, v74
    v_mfma_f32_16x16x32_bf16 v[100:103], a[96:99], a[180:183], v[100:103]
    ds_read2st64_b32 v[44:45], v37 offset0:4 offset1:5
    v_fmac_f32 v195, s60, v75
    v_mfma_f32_16x16x32_bf16 v[136:139], a[96:99], a[168:171], v[136:139]
    ds_read2st64_b32 v[46:47], v37 offset0:6 offset1:7
    v_cvt_pk_bf16_f32 v29, v194, v195
    v_mfma_f32_16x16x32_bf16 v[136:139], a[100:103], a[172:175], v[136:139]
    ds_write_b64 v4, v[28:29] offset:8200
    v_mfma_f32_16x16x32_bf16 v[136:139], a[104:107], a[176:179], v[136:139]
    ds_read_b128 v[188:191], v13 offset:8192
    v_fmac_f32 v204, s60, v84
    v_mfma_f32_16x16x32_bf16 v[136:139], a[108:111], a[180:183], v[136:139]
    ds_write_b64 v4, v[32:33] offset:8192
    v_mfma_f32_16x16x32_bf16 v[136:139], a[112:115], a[184:187], v[136:139]
    ds_read2st64_b32 v[48:49], v37 offset0:8 offset1:9
    v_fmac_f32 v205, s60, v85
    v_mfma_f32_16x16x32_bf16 v[148:151], a[112:115], a[188:191], v[148:151]
    ds_read2st64_b32 v[50:51], v37 offset0:10 offset1:11
    v_cvt_pk_bf16_f32 v34, v204, v205
    v_mfma_f32_16x16x32_bf16 v[148:151], a[108:111], a[184:187], v[148:151]
    buffer_store_dwordx4 v[160:163], v8, s[36:39], s65 offen offset:64 sc0 sc1
    v_mfma_f32_16x16x32_bf16 v[148:151], a[104:107], a[180:183], v[148:151]
    ds_read2st64_b32 v[52:53], v37 offset0:12 offset1:13
    s_waitcnt lgkmcnt(9)
    v_mfma_f32_16x16x32_bf16 v[148:151], a[100:103], a[176:179], v[148:151]
    ds_read2st64_b32 v[54:55], v37 offset0:14 offset1:15
    v_fmac_f32 v206, s60, v86
    v_mfma_f32_16x16x32_bf16 v[148:151], a[96:99], a[172:175], v[148:151]
    s_waitcnt vmcnt(22)
    v_fmac_f32 v207, s60, v87
    v_cvt_pk_bf16_f32 v35, v206, v207
    v_mfma_f32_16x16x32_bf16 v[88:91], a[116:119], a[208:211], v[88:91]
    ds_write_b64 v4, v[34:35] offset:8200
    v_mfma_f32_16x16x32_bf16 v[88:91], a[120:123], a[212:215], v[88:91]
    ds_read_b128 v[200:203], v13 offset:8192
    s_waitcnt lgkmcnt(7)
    v_mfma_f32_16x16x32_bf16 v[88:91], a[124:127], a[216:219], v[88:91]
    ds_read2st64_b32 v[56:57], v37 offset0:16 offset1:17
    v_fmac_f32 v164, s59, v116
    v_mfma_f32_16x16x32_bf16 v[88:91], a[128:131], a[220:223], v[88:91]
    ds_read2st64_b32 v[58:59], v37 offset0:18 offset1:19
    v_fmac_f32 v165, s59, v117
    v_mfma_f32_16x16x32_bf16 v[88:91], a[132:135], a[224:227], v[88:91]
    ds_read2st64_b32 v[60:61], v37 offset0:20 offset1:21
    v_cvt_pk_bf16_f32 v234, v164, v165
    v_mfma_f32_16x16x32_bf16 v[100:103], a[132:135], a[228:231], v[100:103]
    ds_read2st64_b32 v[62:63], v37 offset0:22 offset1:23
    v_fmac_f32 v166, s59, v118
    v_mfma_f32_16x16x32_bf16 v[100:103], a[128:131], a[224:227], v[100:103]
    buffer_store_dwordx4 v[188:191], v6, s[36:39], s66 offen offset:0 sc0 sc1
    v_mfma_f32_16x16x32_bf16 v[100:103], a[124:127], a[220:223], v[100:103]
    v_fmac_f32 v167, s59, v119
    v_cvt_pk_bf16_f32 v235, v166, v167
    v_mfma_f32_16x16x32_bf16 v[100:103], a[120:123], a[216:219], v[100:103]
    ds_write_b64 v4, v[234:235] offset:8192
    v_mfma_f32_16x16x32_bf16 v[100:103], a[116:119], a[212:215], v[100:103]
    s_waitcnt lgkmcnt(5)
    v_fmac_f32 v176, s59, v128
    v_fmac_f32 v177, s59, v129
    v_mfma_f32_16x16x32_bf16 v[136:139], a[116:119], a[200:203], v[136:139]
    v_cvt_pk_bf16_f32 v240, v176, v177
    v_fmac_f32 v178, s59, v130
    v_mfma_f32_16x16x32_bf16 v[136:139], a[120:123], a[204:207], v[136:139]
    v_fmac_f32 v179, s59, v131
    v_cvt_pk_bf16_f32 v241, v178, v179
    v_mfma_f32_16x16x32_bf16 v[136:139], a[124:127], a[208:211], v[136:139]
    s_waitcnt lgkmcnt(1)
    v_fmac_f32 v168, s59, v120
    v_fmac_f32 v169, s59, v121
    v_mfma_f32_16x16x32_bf16 v[136:139], a[128:131], a[212:215], v[136:139]
    v_cvt_pk_bf16_f32 v236, v168, v169
    v_fmac_f32 v170, s59, v122
    v_mfma_f32_16x16x32_bf16 v[136:139], a[132:135], a[216:219], v[136:139]
    v_fmac_f32 v171, s59, v123
    v_cvt_pk_bf16_f32 v237, v170, v171
    v_mfma_f32_16x16x32_bf16 v[148:151], a[132:135], a[220:223], v[148:151]
    ds_write_b64 v4, v[236:237] offset:8200
    v_mfma_f32_16x16x32_bf16 v[148:151], a[128:131], a[216:219], v[148:151]
    buffer_store_dwordx4 v[200:203], v7, s[36:39], s66 offen offset:0 sc0 sc1
    v_mfma_f32_16x16x32_bf16 v[148:151], a[124:127], a[212:215], v[148:151]
    ds_read_b128 v[164:167], v13 offset:8192
    v_fmac_f32 v180, s59, v132
    v_mfma_f32_16x16x32_bf16 v[148:151], a[120:123], a[208:211], v[148:151]
    ds_write_b64 v4, v[240:241] offset:8192
    v_mfma_f32_16x16x32_bf16 v[148:151], a[116:119], a[204:207], v[148:151]
    s_waitcnt vmcnt(19)
    v_fmac_f32 v181, s59, v133
    v_cvt_pk_bf16_f32 v242, v180, v181
    v_mfma_f32_16x16x32_bf16 v[92:95], a[136:139], a[176:179], v[92:95]
    v_fmac_f32 v182, s59, v134
    v_fmac_f32 v183, s59, v135
    v_mfma_f32_16x16x32_bf16 v[92:95], a[140:143], a[180:183], v[92:95]
    v_cvt_pk_bf16_f32 v243, v182, v183
    v_add_f32 v88, v88, v40
    v_mfma_f32_16x16x32_bf16 v[92:95], a[144:147], a[184:187], v[92:95]
    ds_write_b64 v4, v[242:243] offset:8200
    v_mfma_f32_16x16x32_bf16 v[92:95], a[148:151], a[188:191], v[92:95]
    ds_read_b128 v[176:179], v13 offset:8192
    v_add_f32 v89, v89, v41
    v_mfma_f32_16x16x32_bf16 v[92:95], a[152:155], a[192:195], v[92:95]
    s_waitcnt lgkmcnt(3)
    v_cvt_pk_bf16_f32 v244, v88, v89
    v_add_f32 v90, v90, v42
    v_mfma_f32_16x16x32_bf16 v[104:107], a[152:155], a[196:199], v[104:107]
    ds_write_b32 v5, v244 offset:6144
    v_mfma_f32_16x16x32_bf16 v[104:107], a[148:151], a[192:195], v[104:107]
    buffer_store_dwordx4 v[164:167], v6, s[36:39], s65 offen offset:0 sc0 sc1
    v_mfma_f32_16x16x32_bf16 v[104:107], a[144:147], a[188:191], v[104:107]
    v_add_f32 v91, v91, v43
    v_cvt_pk_bf16_f32 v245, v90, v91
    v_mfma_f32_16x16x32_bf16 v[104:107], a[140:143], a[184:187], v[104:107]
    ds_write_b32 v5, v245 offset:6148
    v_mfma_f32_16x16x32_bf16 v[104:107], a[136:139], a[180:183], v[104:107]
    v_add_f32 v100, v100, v52
    v_add_f32 v101, v101, v53
    v_mfma_f32_16x16x32_bf16 v[140:143], a[136:139], a[168:171], v[140:143]
    s_waitcnt lgkmcnt(2)
    v_cvt_pk_bf16_f32 v250, v100, v101
    v_add_f32 v102, v102, v54
    v_mfma_f32_16x16x32_bf16 v[140:143], a[140:143], a[172:175], v[140:143]
    ds_write_b32 v5, v250 offset:15616
    v_mfma_f32_16x16x32_bf16 v[140:143], a[144:147], a[176:179], v[140:143]
    v_add_f32 v103, v103, v55
    v_cvt_pk_bf16_f32 v251, v102, v103
    v_mfma_f32_16x16x32_bf16 v[140:143], a[148:151], a[180:183], v[140:143]
    ds_write_b32 v5, v251 offset:15620
    v_mfma_f32_16x16x32_bf16 v[140:143], a[152:155], a[184:187], v[140:143]
    v_fmac_f32 v136, s58, v64
    v_fmac_f32 v137, s58, v65
    v_mfma_f32_16x16x32_bf16 v[152:155], a[152:155], a[188:191], v[152:155]
    v_cvt_pk_bf16_f32 v24, v136, v137
    v_fmac_f32 v138, s58, v66
    v_mfma_f32_16x16x32_bf16 v[152:155], a[148:151], a[184:187], v[152:155]
    ds_write_b32 v5, v24 offset:7168
    v_mfma_f32_16x16x32_bf16 v[152:155], a[144:147], a[180:183], v[152:155]
    buffer_store_dwordx4 v[176:179], v7, s[36:39], s65 offen offset:0 sc0 sc1
    v_mfma_f32_16x16x32_bf16 v[152:155], a[140:143], a[176:179], v[152:155]
    v_fmac_f32 v139, s58, v67
    v_cvt_pk_bf16_f32 v25, v138, v139
    v_mfma_f32_16x16x32_bf16 v[152:155], a[136:139], a[172:175], v[152:155]
    s_waitcnt vmcnt(16)
    v_fmac_f32 v148, s58, v76
    v_fmac_f32 v149, s58, v77
    v_mfma_f32_16x16x32_bf16 v[92:95], a[156:159], a[208:211], v[92:95]
    ds_write_b32 v5, v25 offset:7172
    v_mfma_f32_16x16x32_bf16 v[92:95], a[160:163], a[212:215], v[92:95]
    v_cvt_pk_bf16_f32 v30, v148, v149
    v_fmac_f32 v150, s58, v78
    v_mfma_f32_16x16x32_bf16 v[92:95], a[164:167], a[216:219], v[92:95]
L_pad4:
    s_cbranch_vccz L_ret4
    ds_write_b32 v5, v30 offset:16640
    v_mfma_f32_16x16x32_bf16 v[92:95], a[0:3], a[220:223], v[92:95]
    v_fmac_f32 v151, s58, v79
    v_cvt_pk_bf16_f32 v31, v150, v151
    v_mfma_f32_16x16x32_bf16 v[92:95], a[4:7], a[224:227], v[92:95]
    s_waitcnt vmcnt(11)
    v_mfma_f32_16x16x32_bf16 v[96:99], a[24:27], a[192:195], v[96:99]
    ds_write_b32 v5, v31 offset:16644
    v_mfma_f32_16x16x32_bf16 v[96:99], a[20:23], a[188:191], v[96:99]
    v_mfma_f32_16x16x32_bf16 v[96:99], a[16:19], a[184:187], v[96:99]
    v_mfma_f32_16x16x32_bf16 v[96:99], a[12:15], a[180:183], v[96:99]
    v_mfma_f32_16x16x32_bf16 v[96:99], a[8:11], a[176:179], v[96:99]
    s_waitcnt vmcnt(6)
    v_mfma_f32_16x16x32_bf16 v[96:99], a[28:31], a[208:211], v[96:99]
    v_add_f32 v92, v92, v44
    v_add_f32 v93, v93, v45
    v_mfma_f32_16x16x32_bf16 v[96:99], a[32:35], a[212:215], v[96:99]
    s_waitcnt lgkmcnt(0)
    s_barrier
    v_mfma_f32_16x16x32_bf16 v[96:99], a[36:39], a[216:219], v[96:99]
    ds_read_b128 v[88:91], v13 offset:6144
    v_cvt_pk_bf16_f32 v246, v92, v93
    v_mfma_f32_16x16x32_bf16 v[96:99], a[40:43], a[220:223], v[96:99]
    ds_write_b32 v4, v246 offset:0
    v_mfma_f32_16x16x32_bf16 v[96:99], a[44:47], a[224:227], v[96:99]
    ds_read_b128 v[136:139], v13 offset:7168
    v_add_f32 v94, v94, v46
    v_mfma_f32_16x16x32_bf16 v[104:107], a[4:7], a[228:231], v[104:107]
    v_add_f32 v95, v95, v47
    v_cvt_pk_bf16_f32 v247, v94, v95
    v_mfma_f32_16x16x32_bf16 v[104:107], a[0:3], a[224:227], v[104:107]
    ds_write_b32 v4, v247 offset:4
    v_mfma_f32_16x16x32_bf16 v[104:107], a[164:167], a[220:223], v[104:107]
    v_mfma_f32_16x16x32_bf16 v[104:107], a[160:163], a[216:219], v[104:107]
    v_mfma_f32_16x16x32_bf16 v[104:107], a[156:159], a[212:215], v[104:107]
    s_waitcnt lgkmcnt(3)
    v_mfma_f32_16x16x32_bf16 v[108:111], a[8:11], a[180:183], v[108:111]
    buffer_store_dwordx4 v[88:91], v8, s[36:39], s67 offen offset:64 sc0 sc1
    v_mfma_f32_16x16x32_bf16 v[108:111], a[12:15], a[184:187], v[108:111]
    s_waitcnt lgkmcnt(1)
    v_add_f32 v96, v96, v48
    v_add_f32 v97, v97, v49
    v_mfma_f32_16x16x32_bf16 v[108:111], a[16:19], a[188:191], v[108:111]
    v_cvt_pk_bf16_f32 v248, v96, v97
    v_add_f32 v98, v98, v50
    v_mfma_f32_16x16x32_bf16 v[108:111], a[20:23], a[192:195], v[108:111]
    ds_write_b32 v4, v248 offset:8
    v_mfma_f32_16x16x32_bf16 v[108:111], a[24:27], a[196:199], v[108:111]
    v_add_f32 v99, v99, v51
    v_cvt_pk_bf16_f32 v249, v98, v99
    v_mfma_f32_16x16x32_bf16 v[108:111], a[44:47], a[228:231], v[108:111]
    ds_write_b32 v4, v249 offset:12
    v_mfma_f32_16x16x32_bf16 v[108:111], a[40:43], a[224:227], v[108:111]
    ds_read_b128 v[92:95], v13 offset:0
    v_add_f32 v104, v104, v56
    v_mfma_f32_16x16x32_bf16 v[108:111], a[36:39], a[220:223], v[108:111]
    v_add_f32 v105, v105, v57
    v_cvt_pk_bf16_f32 v252, v104, v105
    v_mfma_f32_16x16x32_bf16 v[108:111], a[32:35], a[216:219], v[108:111]
    ds_write_b32 v4, v252 offset:1024
    v_mfma_f32_16x16x32_bf16 v[108:111], a[28:31], a[212:215], v[108:111]
    v_add_f32 v106, v106, v58
    v_add_f32 v107, v107, v59
    v_mfma_f32_16x16x32_bf16 v[140:143], a[156:159], a[200:203], v[140:143]
    buffer_store_dwordx4 v[136:139], v8, s[36:39], s64 offen offset:64 sc0 sc1
    v_mfma_f32_16x16x32_bf16 v[140:143], a[160:163], a[204:207], v[140:143]
    v_cvt_pk_bf16_f32 v253, v106, v107
    v_mfma_f32_16x16x32_bf16 v[140:143], a[164:167], a[208:211], v[140:143]
    ds_write_b32 v4, v253 offset:1028
    v_mfma_f32_16x16x32_bf16 v[140:143], a[0:3], a[212:215], v[140:143]
    s_waitcnt lgkmcnt(2)
    v_mfma_f32_16x16x32_bf16 v[140:143], a[4:7], a[216:219], v[140:143]
    v_mfma_f32_16x16x32_bf16 v[144:147], a[24:27], a[184:187], v[144:147]
    v_add_f32 v108, v108, v60
    v_add_f32 v109, v109, v61
    v_mfma_f32_16x16x32_bf16 v[144:147], a[20:23], a[180:183], v[144:147]
    v_cvt_pk_bf16_f32 v254, v108, v109
    v_add_f32 v110, v110, v62
    v_mfma_f32_16x16x32_bf16 v[144:147], a[16:19], a[176:179], v[144:147]
    ds_write_b32 v4, v254 offset:1032
    v_mfma_f32_16x16x32_bf16 v[144:147], a[12:15], a[172:175], v[144:147]
    v_add_f32 v111, v111, v63
    v_cvt_pk_bf16_f32 v255, v110, v111
    v_mfma_f32_16x16x32_bf16 v[144:147], a[8:11], a[168:171], v[144:147]
    ds_write_b32 v4, v255 offset:1036
    v_mfma_f32_16x16x32_bf16 v[144:147], a[28:31], a[200:203], v[144:147]
    buffer_store_dwordx4 v[92:95], v6, s[36:39], s67 offen offset:0 sc0 sc1
    v_mfma_f32_16x16x32_bf16 v[144:147], a[32:35], a[204:207], v[144:147]
    ds_read_b128 v[104:107], v13 offset:1024
    v_fmac_f32 v140, s58, v68
    v_mfma_f32_16x16x32_bf16 v[144:147], a[36:39], a[208:211], v[144:147]
    v_fmac_f32 v141, s58, v69
    v_cvt_pk_bf16_f32 v26, v140, v141
    v_mfma_f32_16x16x32_bf16 v[144:147], a[40:43], a[212:215], v[144:147]
    ds_write_b32 v4, v26 offset:2048
    v_mfma_f32_16x16x32_bf16 v[144:147], a[44:47], a[216:219], v[144:147]
    v_fmac_f32 v142, s58, v70
    v_fmac_f32 v143, s58, v71
    v_mfma_f32_16x16x32_bf16 v[152:155], a[4:7], a[220:223], v[152:155]
    v_cvt_pk_bf16_f32 v27, v142, v143
    v_mfma_f32_16x16x32_bf16 v[152:155], a[0:3], a[216:219], v[152:155]
    ds_write_b32 v4, v27 offset:2052
    v_mfma_f32_16x16x32_bf16 v[152:155], a[164:167], a[212:215], v[152:155]
    v_mfma_f32_16x16x32_bf16 v[152:155], a[160:163], a[208:211], v[152:155]
    s_waitcnt lgkmcnt(2)
    v_mfma_f32_16x16x32_bf16 v[152:155], a[156:159], a[204:207], v[152:155]
    v_mfma_f32_16x16x32_bf16 v[156:159], a[8:11], a[172:175], v[156:159]
    buffer_store_dwordx4 v[104:107], v7, s[36:39], s67 offen offset:0 sc0 sc1
    v_mfma_f32_16x16x32_bf16 v[156:159], a[12:15], a[176:179], v[156:159]
    v_fmac_f32 v144, s58, v72
    v_fmac_f32 v145, s58, v73
    v_mfma_f32_16x16x32_bf16 v[156:159], a[16:19], a[180:183], v[156:159]
    v_cvt_pk_bf16_f32 v28, v144, v145
    v_fmac_f32 v146, s58, v74
    v_mfma_f32_16x16x32_bf16 v[156:159], a[20:23], a[184:187], v[156:159]
    ds_write_b32 v4, v28 offset:2056
    v_mfma_f32_16x16x32_bf16 v[156:159], a[24:27], a[188:191], v[156:159]
    v_fmac_f32 v147, s58, v75
    v_cvt_pk_bf16_f32 v29, v146, v147
    v_mfma_f32_16x16x32_bf16 v[156:159], a[44:47], a[220:223], v[156:159]
    ds_write_b32 v4, v29 offset:2060
    v_mfma_f32_16x16x32_bf16 v[156:159], a[40:43], a[216:219], v[156:159]
    ds_read_b128 v[140:143], v13 offset:2048
    v_fmac_f32 v152, s58, v80
    v_mfma_f32_16x16x32_bf16 v[156:159], a[36:39], a[212:215], v[156:159]
    v_fmac_f32 v153, s58, v81
    v_cvt_pk_bf16_f32 v32, v152, v153
    v_mfma_f32_16x16x32_bf16 v[156:159], a[32:35], a[208:211], v[156:159]
    v_fmac_f32 v154, s58, v82
    v_fmac_f32 v155, s58, v83
    v_mfma_f32_16x16x32_bf16 v[156:159], a[28:31], a[204:207], v[156:159]
    v_cvt_pk_bf16_f32 v33, v154, v155
    ds_write_b64 v4, v[32:33] offset:3072
    s_nop 5
    v_fmac_f32 v156, s58, v84
    v_fmac_f32 v157, s58, v85
    v_cvt_pk_bf16_f32 v34, v156, v157
    v_fmac_f32 v158, s58, v86
    v_fmac_f32 v159, s58, v87
    v_cvt_pk_bf16_f32 v35, v158, v159
    ds_write_b64 v4, v[34:35] offset:3080
    ds_read_b128 v[152:155], v13 offset:3072
    s_waitcnt lgkmcnt(3)
    buffer_store_dwordx4 v[140:143], v6, s[36:39], s64 offen offset:0 sc0 sc1
    s_waitcnt lgkmcnt(0)
    buffer_store_dwordx4 v[152:155], v7, s[36:39], s64 offen offset:0 sc0 sc1
    s_endpgm
L_slow:
    s_mov_b32 s3, 0
    s_mov_b32 s34, 737280
    v_add_u32 v23, s18, v2
    buffer_load_dword v31, v3, s[40:43], 0 offen offset:0 sc1
L_poll:
    s_waitcnt vmcnt(0)
    v_readfirstlane_b32 s50, v31
    s_add_u32 s3, s3, 1
    s_cmp_ge_u32 s3, 0x10000
    s_cselect_b32 s50, 30, s50
    s_cmp_ge_u32 s50, 10
    s_cbranch_scc1 L_ready
    s_sleep 4
    buffer_load_dword v31, v3, s[40:43], 0 offen offset:0 sc1
    s_branch L_poll
L_ready:
    buffer_load_dwordx4 a[0:3], v23, s[32:35], 0 offen offset:0 sc1
    buffer_load_dwordx4 a[4:7], v23, s[32:35], 0 offen offset:1024 sc1
    buffer_load_dwordx4 a[8:11], v23, s[32:35], 0 offen offset:2048 sc1
    buffer_load_dwordx4 a[12:15], v23, s[32:35], 0 offen offset:3072 sc1
    v_add_u32 v23, 4096, v23
    buffer_load_dwordx4 a[16:19], v23, s[32:35], 0 offen offset:0 sc1
    buffer_load_dwordx4 a[20:23], v23, s[32:35], 0 offen offset:1024 sc1
    buffer_load_dwordx4 a[24:27], v23, s[32:35], 0 offen offset:2048 sc1
    buffer_load_dwordx4 a[28:31], v23, s[32:35], 0 offen offset:3072 sc1
    v_add_u32 v23, 4096, v23
    buffer_load_dwordx4 a[32:35], v23, s[32:35], 0 offen offset:0 sc1
    s_branch L_go
L_slow2:
    s_mov_b32 s51, 0
L_poll2:
    s_sleep 4
    buffer_load_dword v30, v3, s[40:43], 0 offen offset:128 sc1
    s_waitcnt vmcnt(0)
    v_readfirstlane_b32 s50, v30
    s_add_u32 s51, s51, 1
    s_cmp_ge_u32 s51, 0x10000
    s_cselect_b32 s50, 30, s50
    s_cmp_lt_u32 s50, 30
    s_cbranch_scc1 L_poll2
    s_branch L_go2
L_prod2:
    s_mov_b32 s32, s16
    s_mov_b32 s33, s17
    s_mov_b32 s34, 737280
    s_mov_b32 s35, 0x20000
    s_mov_b32 s40, s14
    s_mov_b32 s41, s15
    s_mov_b32 s42, 256
    s_mov_b32 s43, 0x20000
    s_lshl_b32 s56, s19, 3
    s_sub_u32 s56, s56, 8
    s_cmp_eq_u32 s19, 0
    s_cselect_b32 s55, 3, 4
    s_cselect_b32 s56, 64, s56
    s_cselect_b32 s59, 5, 7
    s_lshl_b32 s57, s52, 9
    s_mul_i32 s3, s51, 15360
    s_add_u32 s57, s57, s3
    s_mul_i32 s3, s19, 5120
    s_add_u32 s57, s57, s3
    s_lshl_b32 s3, s50, 10
    s_sub_u32 s60, s57, s3
    s_add_u32 s57, s57, s3
    s_mov_b32 s58, 0xffff0000
    v_bfe_u32 v5, v1, 2, 3
    v_mul_u32_u24 v5, 192, v5
    v_and_b32 v6, 3, v1
    v_lshlrev_b32 v6, s55, v6
    v_add3_u32 v5, v5, v6, s56
    v_lshrrev_b32 v6, 5, v1
    v_lshlrev_b32 v7, s59, v6
    v_add_u32 v5, v5, v7
    v_mul_u32_u24 v6, 368128, v6
    v_add_u32 v3, v2, v6
    v_mov_b32 v128, 0xbe638e39
    v_mov_b32 v129, 0xbe638e39
    v_mov_b32 v130, 0x3e800000
    v_mov_b32 v131, 0x3e800000
    v_mov_b32 v132, 0x3d800000
    v_mov_b32 v133, 0x3d800000
    v_mov_b32 v134, 0x3f000000
    v_mov_b32 v135, 0x3f000000
    v_mov_b32 v136, 0x40800000
    v_mov_b32 v137, 0x40800000
    v_mov_b32 v138, 0x41800000
    v_mov_b32 v139, 0x41800000
    v_mov_b32 v140, 0x40000000
    v_mov_b32 v141, 0x40000000
    s_waitcnt vmcnt(0)
    s_barrier
    ds_read_b64_tr_b16 v[8:9], v5 offset:0
    ds_read_b64_tr_b16 v[10:11], v5 offset:1536
    ds_read_b64_tr_b16 v[12:13], v5 offset:3072
    ds_read_b64_tr_b16 v[14:15], v5 offset:4608
    ds_read_b64_tr_b16 v[16:17], v5 offset:6144
    ds_read_b64_tr_b16 v[18:19], v5 offset:7680
    ds_read_b64_tr_b16 v[20:21], v5 offset:9216
    ds_read_b64_tr_b16 v[22:23], v5 offset:10752
    ds_read_b64_tr_b16 v[24:25], v5 offset:12288
    ds_read_b64_tr_b16 v[26:27], v5 offset:13824
    s_mul_i32 s3, s51, 3
    s_add_u32 s3, s3, s19
    s_mov_b32 s61, 0
    s_cmp_eq_u32 s3, 4
    s_cselect_b32 s61, 5120, s61
    s_cmp_eq_u32 s3, 5
    s_cselect_b32 s61, 10240, s61
    s_cmp_eq_u32 s3, 6
    s_cselect_b32 s61, -10240, s61
    s_cmp_eq_u32 s3, 7
    s_cselect_b32 s61, -5120, s61
    s_waitcnt lgkmcnt(9)
    v_lshlrev_b32 v32, 16, v8
    v_and_b32 v33, s58, v8
    v_lshlrev_b32 v34, 16, v9
    v_and_b32 v35, s58, v9
    s_waitcnt lgkmcnt(8)
    v_lshlrev_b32 v36, 16, v10
    v_and_b32 v37, s58, v10
    v_lshlrev_b32 v38, 16, v11
    v_and_b32 v39, s58, v11
    s_waitcnt lgkmcnt(7)
    v_lshlrev_b32 v40, 16, v12
    v_and_b32 v41, s58, v12
    v_lshlrev_b32 v42, 16, v13
    v_and_b32 v43, s58, v13
    s_waitcnt lgkmcnt(6)
    v_lshlrev_b32 v44, 16, v14
    v_and_b32 v45, s58, v14
    v_lshlrev_b32 v46, 16, v15
    v_and_b32 v47, s58, v15
    s_waitcnt lgkmcnt(5)
    v_lshlrev_b32 v48, 16, v16
    v_and_b32 v49, s58, v16
    v_lshlrev_b32 v50, 16, v17
    v_and_b32 v51, s58, v17
    s_waitcnt lgkmcnt(4)
    v_lshlrev_b32 v52, 16, v18
    v_and_b32 v53, s58, v18
    v_lshlrev_b32 v54, 16, v19
    v_and_b32 v55, s58, v19
    s_waitcnt lgkmcnt(3)
    v_lshlrev_b32 v56, 16, v20
    v_and_b32 v57, s58, v20
    v_lshlrev_b32 v58, 16, v21
    v_and_b32 v59, s58, v21
    s_waitcnt lgkmcnt(2)
    v_lshlrev_b32 v60, 16, v22
    v_and_b32 v61, s58, v22
    v_lshlrev_b32 v62, 16, v23
    v_and_b32 v63, s58, v23
    s_waitcnt lgkmcnt(1)
    v_lshlrev_b32 v64, 16, v24
    v_and_b32 v65, s58, v24
    v_lshlrev_b32 v66, 16, v25
    v_and_b32 v67, s58, v25
    s_waitcnt lgkmcnt(0)
    v_lshlrev_b32 v68, 16, v26
    v_and_b32 v69, s58, v26
    v_lshlrev_b32 v70, 16, v27
    v_and_b32 v71, s58, v27
    v_pk_add_f32 v[72:73], v[32:33], v[48:49]
    v_pk_add_f32 v[74:75], v[34:35], v[50:51]
    v_pk_add_f32 v[76:77], v[36:37], v[52:53]
    v_pk_add_f32 v[78:79], v[38:39], v[54:55]
    v_pk_add_f32 v[80:81], v[40:41], v[56:57]
    v_pk_add_f32 v[82:83], v[42:43], v[58:59]
    v_pk_add_f32 v[84:85], v[44:45], v[60:61]
    v_pk_add_f32 v[86:87], v[46:47], v[62:63]
    v_pk_add_f32 v[72:73], v[72:73], v[64:65]
    v_pk_add_f32 v[74:75], v[74:75], v[66:67]
    v_pk_add_f32 v[76:77], v[76:77], v[68:69]
    v_pk_add_f32 v[78:79], v[78:79], v[70:71]
    v_pk_mul_f32 v[72:73], v[72:73], v[128:129]
    v_pk_mul_f32 v[74:75], v[74:75], v[128:129]
    v_pk_mul_f32 v[76:77], v[76:77], v[128:129]
    v_pk_mul_f32 v[78:79], v[78:79], v[128:129]
    v_pk_fma_f32 v[88:89], v[80:81], v[128:129], v[72:73]
    v_pk_fma_f32 v[90:91], v[82:83], v[128:129], v[74:75]
    v_pk_fma_f32 v[92:93], v[84:85], v[128:129], v[76:77]
    v_pk_fma_f32 v[94:95], v[86:87], v[128:129], v[78:79]
    v_pk_fma_f32 v[96:97], v[80:81], v[128:129], v[72:73] neg_lo:[1,0,0] neg_hi:[1,0,0]
    v_pk_fma_f32 v[98:99], v[82:83], v[128:129], v[74:75] neg_lo:[1,0,0] neg_hi:[1,0,0]
    v_pk_fma_f32 v[100:101], v[84:85], v[128:129], v[76:77] neg_lo:[1,0,0] neg_hi:[1,0,0]
    v_pk_fma_f32 v[102:103], v[86:87], v[128:129], v[78:79] neg_lo:[1,0,0] neg_hi:[1,0,0]
    v_cvt_pk_bf16_f32 v104, v88, v89
    v_cvt_pk_bf16_f32 v108, v96, v97
    v_cvt_pk_bf16_f32 v105, v90, v91
    v_cvt_pk_bf16_f32 v109, v98, v99
    v_cvt_pk_bf16_f32 v106, v92, v93
    v_cvt_pk_bf16_f32 v110, v100, v101
    v_cvt_pk_bf16_f32 v107, v94, v95
    v_cvt_pk_bf16_f32 v111, v102, v103
    s_add_u32 s3, s57, 0
    buffer_store_dwordx4 v[104:107], v3, s[32:35], s3 offen offset:0 sc1
    s_add_u32 s3, s60, 188416
    buffer_store_dwordx4 v[108:111], v3, s[32:35], s3 offen offset:0 sc1
    v_pk_fma_f32 v[72:73], v[48:49], v[130:131], v[32:33]
    v_pk_fma_f32 v[74:75], v[50:51], v[130:131], v[34:35]
    v_pk_fma_f32 v[76:77], v[52:53], v[130:131], v[36:37]
    v_pk_fma_f32 v[78:79], v[54:55], v[130:131], v[38:39]
    v_pk_fma_f32 v[80:81], v[56:57], v[130:131], v[40:41]
    v_pk_fma_f32 v[82:83], v[58:59], v[130:131], v[42:43]
    v_pk_fma_f32 v[84:85], v[60:61], v[130:131], v[44:45]
    v_pk_fma_f32 v[86:87], v[62:63], v[130:131], v[46:47]
    v_pk_fma_f32 v[72:73], v[64:65], v[132:133], v[72:73]
    v_pk_fma_f32 v[74:75], v[66:67], v[132:133], v[74:75]
    v_pk_fma_f32 v[76:77], v[68:69], v[132:133], v[76:77]
    v_pk_fma_f32 v[78:79], v[70:71], v[132:133], v[78:79]
    v_pk_fma_f32 v[88:89], v[80:81], v[134:135], v[72:73]
    v_pk_fma_f32 v[90:91], v[82:83], v[134:135], v[74:75]
    v_pk_fma_f32 v[92:93], v[84:85], v[134:135], v[76:77]
    v_pk_fma_f32 v[94:95], v[86:87], v[134:135], v[78:79]
    v_pk_fma_f32 v[96:97], v[80:81], v[134:135], v[72:73] neg_lo:[1,0,0] neg_hi:[1,0,0]
    v_pk_fma_f32 v[98:99], v[82:83], v[134:135], v[74:75] neg_lo:[1,0,0] neg_hi:[1,0,0]
    v_pk_fma_f32 v[100:101], v[84:85], v[134:135], v[76:77] neg_lo:[1,0,0] neg_hi:[1,0,0]
    v_pk_fma_f32 v[102:103], v[86:87], v[134:135], v[78:79] neg_lo:[1,0,0] neg_hi:[1,0,0]
    v_cvt_pk_bf16_f32 v112, v88, v89
    v_cvt_pk_bf16_f32 v116, v96, v97
    v_cvt_pk_bf16_f32 v113, v90, v91
    v_cvt_pk_bf16_f32 v117, v98, v99
    v_cvt_pk_bf16_f32 v114, v92, v93
    v_cvt_pk_bf16_f32 v118, v100, v101
    v_cvt_pk_bf16_f32 v115, v94, v95
    v_cvt_pk_bf16_f32 v119, v102, v103
    s_add_u32 s3, s57, 46080
    buffer_store_dwordx4 v[112:115], v3, s[32:35], s3 offen offset:0 sc1
    s_add_u32 s3, s60, 234496
    buffer_store_dwordx4 v[116:119], v3, s[32:35], s3 offen offset:0 sc1
    v_pk_fma_f32 v[72:73], v[48:49], v[136:137], v[32:33]
    v_pk_fma_f32 v[74:75], v[50:51], v[136:137], v[34:35]
    v_pk_fma_f32 v[76:77], v[52:53], v[136:137], v[36:37]
    v_pk_fma_f32 v[78:79], v[54:55], v[136:137], v[38:39]
    v_pk_fma_f32 v[80:81], v[56:57], v[136:137], v[40:41]
    v_pk_fma_f32 v[82:83], v[58:59], v[136:137], v[42:43]
    v_pk_fma_f32 v[84:85], v[60:61], v[136:137], v[44:45]
    v_pk_fma_f32 v[86:87], v[62:63], v[136:137], v[46:47]
    v_pk_fma_f32 v[72:73], v[64:65], v[138:139], v[72:73]
    v_pk_fma_f32 v[74:75], v[66:67], v[138:139], v[74:75]
    v_pk_fma_f32 v[76:77], v[68:69], v[138:139], v[76:77]
    v_pk_fma_f32 v[78:79], v[70:71], v[138:139], v[78:79]
    v_pk_fma_f32 v[88:89], v[80:81], v[140:141], v[72:73]
    v_pk_fma_f32 v[90:91], v[82:83], v[140:141], v[74:75]
    v_pk_fma_f32 v[92:93], v[84:85], v[140:141], v[76:77]
    v_pk_fma_f32 v[94:95], v[86:87], v[140:141], v[78:79]
    v_pk_fma_f32 v[96:97], v[80:81], v[140:141], v[72:73] neg_lo:[1,0,0] neg_hi:[1,0,0]
    v_pk_fma_f32 v[98:99], v[82:83], v[140:141], v[74:75] neg_lo:[1,0,0] neg_hi:[1,0,0]
    v_pk_fma_f32 v[100:101], v[84:85], v[140:141], v[76:77] neg_lo:[1,0,0] neg_hi:[1,0,0]
    v_pk_fma_f32 v[102:103], v[86:87], v[140:141], v[78:79] neg_lo:[1,0,0] neg_hi:[1,0,0]
    v_cvt_pk_bf16_f32 v120, v88, v89
    v_cvt_pk_bf16_f32 v124, v96, v97
    v_cvt_pk_bf16_f32 v121, v90, v91
    v_cvt_pk_bf16_f32 v125, v98, v99
    v_cvt_pk_bf16_f32 v122, v92, v93
    v_cvt_pk_bf16_f32 v126, v100, v101
    v_cvt_pk_bf16_f32 v123, v94, v95
    v_cvt_pk_bf16_f32 v127, v102, v103
    s_add_u32 s3, s57, 92160
    s_add_u32 s3, s3, s61
    buffer_store_dwordx4 v[120:123], v3, s[32:35], s3 offen offset:0 sc1
    s_add_u32 s3, s60, 280576
    s_add_u32 s3, s3, s61
    buffer_store_dwordx4 v[124:127], v3, s[32:35], s3 offen offset:0 sc1
    s_add_u32 s3, s57, 138240
    s_add_u32 s3, s3, s61
    buffer_store_dwordx4 v[8:11], v3, s[32:35], s3 offen offset:0 sc1
    s_add_u32 s3, s60, 326656
    s_add_u32 s3, s3, s61
    buffer_store_dwordx4 v[24:27], v3, s[32:35], s3 offen offset:0 sc1
    v_mov_b32 v6, 1
    v_mov_b32 v7, 0
    s_waitcnt vmcnt(6)
    s_barrier
    s_waitcnt vmcnt(0)
    s_barrier
    s_branch L_pwait
L_pidle:
    s_cmp_ge_u32 s2, 30
    s_cbranch_scc1 L_end
    s_waitcnt lgkmcnt(0)
    s_mov_b32 s32, s16
    s_mov_b32 s33, s17
    s_mov_b32 s34, 737280
    s_mov_b32 s35, 0x20000
    s_mov_b32 s40, s14
    s_mov_b32 s41, s15
    s_mov_b32 s42, 256
    s_mov_b32 s43, 0x20000
    v_mov_b32 v6, 1
    v_mov_b32 v7, 0
    s_mov_b64 exec, 1
    s_mov_b32 s3, 0
    s_barrier
    s_barrier
    s_cmp_ge_u32 s2, 10
    s_cbranch_scc1 L_pnoa
    buffer_atomic_add v6, v7, s[40:43], 0 offen sc1
L_pnoa:
    s_barrier
    buffer_atomic_add v6, v7, s[40:43], 0 offen offset:128 sc1
    s_cmp_ge_u32 s2, 24
    s_cbranch_scc1 L_end
    s_waitcnt vmcnt(0)
L_ppoll:
    s_sleep 10
    buffer_load_dword v6, v7, s[40:43], 0 offen offset:128 sc1
    s_add_u32 s3, s3, 1
    s_waitcnt vmcnt(0)
    v_readfirstlane_b32 s52, v6
    s_cmp_ge_u32 s3, 0x8000
    s_nop 0
    s_cselect_b32 s52, 30, s52
    s_cmp_ge_u32 s52, 30
    s_cbranch_scc0 L_ppoll
    s_mov_b64 exec, -1
L_pwait:
    s_cmp_ge_u32 s2, 24
    s_cbranch_scc1 L_end
    s_lshr_b32 s50, s2, 3
    s_lshl_b32 s50, s50, 13
    s_mul_i32 s51, s19, 184320
    s_add_u32 s50, s50, s51
    s_add_u32 s50, s50, 16384
    v_lshlrev_b32 v4, 7, v1
    v_add_u32 v4, s50, v4
    s_barrier
    buffer_load_dword v8, v4, s[32:35], 0 offen offset:0 sc1
    v_add_u32 v4, 24576, v4
    buffer_load_dword v9, v4, s[32:35], 0 offen offset:0 sc1
    v_add_u32 v4, 24576, v4
    buffer_load_dword v10, v4, s[32:35], 0 offen offset:0 sc1
    v_add_u32 v4, 24576, v4
    buffer_load_dword v11, v4, s[32:35], 0 offen offset:0 sc1
    v_add_u32 v4, 24576, v4
    buffer_load_dword v12, v4, s[32:35], 0 offen offset:0 sc1
    v_add_u32 v4, 24576, v4
    buffer_load_dword v13, v4, s[32:35], 0 offen offset:0 sc1
    v_add_u32 v4, 24576, v4
    buffer_load_dword v14, v4, s[32:35], 0 offen offset:0 sc1
    v_add_u32 v4, 24576, v4
    s_endpgm
.p2align 7
.type t_table,@object
t_table:
    .long 0x3f800000, 0xc0883f80, 0xc0503f80, 0x0000c050
    .long 0x00000000, 0x00000000, 0x00000000, 0x00003f80
    .long 0x00000000, 0x00000000, 0x00000000, 0x00000000
    .long 0x00000000, 0x00000000, 0x00000000, 0xc0880000
    .long 0x40000000, 0xc0204080, 0x3fc04000, 0x0000c090
    .long 0x00000000, 0x00000000, 0x00000000, 0x00004000
    .long 0x00000000, 0x00000000, 0x00000000, 0x00000000
    .long 0x00000000, 0x00000000, 0x00000000, 0xc0a00000
    .long 0x3f000000, 0xc0203e80, 0xc0103f00, 0x00003f40
    .long 0x00000000, 0x00000000, 0x00000000, 0x00003f00
    .long 0x00000000, 0x00000000, 0x00000000, 0x00000000
    .long 0x00000000, 0x00000000, 0x00000000, 0xbfa00000
    .long 0x00003f80, 0x0000c0a8, 0xc0a83f80, 0x000040a8
    .long 0x00000000, 0x00000000, 0x00000000, 0x00003f80
    .long 0x00000000, 0x00000000, 0x00000000, 0x00000000
    .long 0x00000000, 0x00000000, 0x00000000, 0x40a80000
    .long 0x3f80c088, 0x00003f80, 0x00003f80, 0x00000000
    .long 0x3f800000, 0xc0883f80, 0xc050c050, 0x00003f80
    .long 0x00000000, 0x00000000, 0x3f800000, 0x0000c050
    .long 0x00000000, 0x00000000, 0x00000000, 0x3f800000
    .long 0x3f00c0a0, 0x00003f80, 0x00003f80, 0x00000000
    .long 0x40000000, 0xc0204080, 0xc0903fc0, 0x00003f80
    .long 0x00000000, 0x00000000, 0x40000000, 0x00003fc0
    .long 0x00000000, 0x00000000, 0x00000000, 0x3f000000
    .long 0x4000bfa0, 0x00003f80, 0x00003f80, 0x00000000
    .long 0x3f000000, 0xc0203e80, 0x3f40c010, 0x00003f80
    .long 0x00000000, 0x00000000, 0x3f000000, 0x0000c010
    .long 0x00000000, 0x00000000, 0x00000000, 0x40000000
    .long 0x000040a8, 0x0000bf80, 0x0000bf80, 0x00000000
    .long 0x00003f80, 0x0000c0a8, 0x40a8c0a8, 0x0000bf80
    .long 0x00000000, 0x00000000, 0x3f800000, 0x0000c0a8
    .long 0x00000000, 0x00000000, 0x00000000, 0x00000000
    .long 0x00000000, 0x00000000, 0x00000000, 0x00000000
    .long 0x3f80c088, 0x00003f80, 0x00000000, 0x00000000
    .long 0x3f800000, 0xc0883f80, 0x3f80c050, 0x00000000
    .long 0x00000000, 0x00000000, 0xc0503f80, 0x3f80c050
    .long 0x00000000, 0x00000000, 0x00000000, 0x00000000
    .long 0x3f00c0a0, 0x00003f80, 0x00000000, 0x00000000
    .long 0x40000000, 0xc0204080, 0x3f80c090, 0x00000000
    .long 0x00000000, 0x00000000, 0x3fc04000, 0x3f80c090
    .long 0x00000000, 0x00000000, 0x00000000, 0x00000000
    .long 0x4000bfa0, 0x00003f80, 0x00000000, 0x00000000
    .long 0x3f000000, 0xc0203e80, 0x3f803f40, 0x00000000
    .long 0x00000000, 0x00000000, 0xc0103f00, 0x3f803f40
    .long 0x00000000, 0x00000000, 0x00000000, 0x00000000
    .long 0x000040a8, 0x0000bf80, 0x00000000, 0x00000000
    .long 0x00003f80, 0x0000c0a8, 0xbf8040a8, 0x00000000
    .long 0x00000000, 0x00000000, 0xc0a83f80, 0xbf8040a8
    .long 0x00000000, 0x00000000, 0x00000000, 0x00000000
    .long 0x00000000, 0x00000000, 0x00000000, 0x00000000
    .long 0x3f80c088, 0x00003f80, 0x00000000, 0x00000000
    .long 0x3f800000, 0xc0883f80, 0x00003f80, 0x00000000
    .long 0x00000000, 0x00000000, 0x00000000, 0x00000000
    .long 0x00000000, 0x00000000, 0x00000000, 0x00000000
    .long 0x3f00c0a0, 0x00003f80, 0x00000000, 0x00000000
    .long 0x40000000, 0xc0204080, 0x00003f80, 0x00000000
    .long 0x00000000, 0x00000000, 0x00000000, 0x00000000
    .long 0x00000000, 0x00000000, 0x00000000, 0x00000000
    .long 0x4000bfa0, 0x00003f80, 0x00000000, 0x00000000
    .long 0x3f000000, 0xc0203e80, 0x00003f80, 0x00000000
    .long 0x00000000, 0x00000000, 0x00000000, 0x00000000
    .long 0x00000000, 0x00000000, 0x00000000, 0x00000000
    .long 0x000040a8, 0x0000bf80, 0x00000000, 0x00000000
    .long 0x00003f80, 0x0000c0a8, 0x0000bf80, 0x00000000
    .long 0xbf800000, 0x40883f80, 0x40a8bf80, 0x0000c0a8
    .long 0x00000000, 0x00000000, 0x00000000, 0x0000bf80
    .long 0x00000000, 0x00000000, 0x00000000, 0x00000000
    .long 0x00000000, 0x00000000, 0x00000000, 0xc0880000
    .long 0xc0000000, 0x40204080, 0x40d0c000, 0x0000c0b0
    .long 0x00000000, 0x00000000, 0x00000000, 0x0000c000
    .long 0x00000000, 0x00000000, 0x00000000, 0x00000000
    .long 0x00000000, 0x00000000, 0x00000000, 0xc0a00000
    .long 0xbf000000, 0x40203e80, 0x4030bf00, 0x0000c050
    .long 0x00000000, 0x00000000, 0x00000000, 0x0000bf00
    .long 0x00000000, 0x00000000, 0x00000000, 0x00000000
    .long 0x00000000, 0x00000000, 0x00000000, 0xbfa00000
    .long 0xbf800000, 0x40a80000, 0x40a8bf80, 0x0000c0a8
    .long 0x00000000, 0x00000000, 0x00000000, 0x0000bf80
    .long 0x00000000, 0x00000000, 0x00000000, 0x00000000
    .long 0x00000000, 0x00000000, 0x00000000, 0x00000000
    .long 0xbf80c088, 0x00003f80, 0x00003f80, 0x00000000
    .long 0xbf800000, 0x40883f80, 0xc0a840a8, 0x00003f80
    .long 0x00000000, 0x00000000, 0xbf800000, 0x000040a8
    .long 0x00000000, 0x00000000, 0x00000000, 0xbf800000
    .long 0xbf00c0a0, 0x00003f80, 0x00003f80, 0x00000000
    .long 0xc0000000, 0x40204080, 0xc0b040d0, 0x00003f80
    .long 0x00000000, 0x00000000, 0xc0000000, 0x000040d0
    .long 0x00000000, 0x00000000, 0x00000000, 0xbf000000
    .long 0xc000bfa0, 0x00003f80, 0x00003f80, 0x00000000
    .long 0xbf000000, 0x40203e80, 0xc0504030, 0x00003f80
    .long 0x00000000, 0x00000000, 0xbf000000, 0x00004030
    .long 0x00000000, 0x00000000, 0x00000000, 0xc0000000
    .long 0xc0a80000, 0x3f800000, 0x00003f80, 0x00000000
    .long 0xbf800000, 0x40a80000, 0xc0a840a8, 0x00003f80
    .long 0x00000000, 0x00000000, 0xbf800000, 0x000040a8
    .long 0x00000000, 0x00000000, 0x00000000, 0xc0a80000
    .long 0x00000000, 0x00000000, 0x00000000, 0x00000000
    .long 0xbf80c088, 0x00003f80, 0x00000000, 0x00000000
    .long 0xbf800000, 0x40883f80, 0x3f80c0a8, 0x00000000
    .long 0x00000000, 0x00000000, 0x40a8bf80, 0x3f80c0a8
    .long 0x00000000, 0x00000000, 0x00000000, 0x00000000
    .long 0xbf00c0a0, 0x00003f80, 0x00000000, 0x00000000
    .long 0xc0000000, 0x40204080, 0x3f80c0b0, 0x00000000
    .long 0x00000000, 0x00000000, 0x40d0c000, 0x3f80c0b0
    .long 0x00000000, 0x00000000, 0x00000000, 0x00000000
    .long 0xc000bfa0, 0x00003f80, 0x00000000, 0x00000000
    .long 0xbf000000, 0x40203e80, 0x3f80c050, 0x00000000
    .long 0x00000000, 0x00000000, 0x4030bf00, 0x3f80c050
    .long 0x00000000, 0x00000000, 0x00000000, 0x00000000
    .long 0xc0a80000, 0x3f800000, 0x00000000, 0x00000000
    .long 0xbf800000, 0x40a80000, 0x3f80c0a8, 0x00000000
    .long 0x00000000, 0x00000000, 0x40a8bf80, 0x0000c0a8
    .long 0x00000000, 0x00000000, 0x00000000, 0x00000000
    .long 0x00000000, 0x00000000, 0x00000000, 0x00000000
    .long 0xbf80c088, 0x00003f80, 0x00000000, 0x00000000
    .long 0xbf800000, 0x40883f80, 0x00003f80, 0x00000000
    .long 0x00000000, 0x00000000, 0x00000000, 0x00000000
    .long 0x00000000, 0x00000000, 0x00000000, 0x00000000
    .long 0xbf00c0a0, 0x00003f80, 0x00000000, 0x00000000
    .long 0xc0000000, 0x40204080, 0x00003f80, 0x00000000
    .long 0x00000000, 0x00000000, 0x00000000, 0x00000000
    .long 0x00000000, 0x00000000, 0x00000000, 0x00000000
    .long 0xc000bfa0, 0x00003f80, 0x00000000, 0x00000000
    .long 0xbf000000, 0x40203e80, 0x00003f80, 0x00000000
    .long 0x00000000, 0x00000000, 0x00000000, 0x00000000
    .long 0x00000000, 0x00000000, 0x00000000, 0x00000000
    .long 0xc0a80000, 0x3f800000, 0x00000000, 0x00000000
    .long 0xbf800000, 0x40a80000, 0x00003f80, 0x3f800000
.size t_table, 2048
code_end:
.section .rodata,"a"
.p2align 6
.amdhsa_kernel standalone__detection_seg_fpn_lateral__vision_kernel
  .amdhsa_next_free_vgpr 512
  .amdhsa_next_free_sgpr 102
  .amdhsa_accum_offset 256
  .amdhsa_group_segment_fixed_size 0
  .amdhsa_kernarg_size 56
  .amdhsa_user_sgpr_count 2
  .amdhsa_user_sgpr_kernarg_segment_ptr 1
  .amdhsa_system_sgpr_workgroup_id_x 1
  .amdhsa_float_denorm_mode_32 3
.end_amdhsa_kernel
```
